```python
import torch

def _softmax(x, axis=-1):
    return torch.softmax(x, dim=axis)
def _gelu(x):
    return torch.nn.functional.gelu(x, approximate="tanh")
def _silu(x):
    return torch.nn.functional.silu(x)
def _sigmoid(x):
    return torch.sigmoid(x)
def _layernorm(x, axis=-1, eps=1e-5):
    m = x.mean(dim=axis, keepdim=True)
    v = x.var(dim=axis, keepdim=True, unbiased=False)
    return (x - m) / torch.sqrt(v + eps)
def _scatter_add(tgt, idx, src, axis=0):
    return tgt.clone().index_add_(axis, idx, src)
def _segment_sum(src, seg, n):
    out = torch.zeros((n,) + src.shape[1:], dtype=src.dtype)
    return out.index_add_(0, seg, src)
def _pad(x, pw):
    flat = tuple(v for pair in reversed(pw) for v in pair)
    return torch.nn.functional.pad(x, flat)

kernel_name = 'gated_mix__mha_block__mha_block__prompt'

def setup_inputs():

    _w = (lambda a: (lambda t: t.to(torch.bfloat16) if t.is_floating_point() else t)(torch.as_tensor(a)))
    def _A_setup():
        B, S, D, H = 1, 2048, 576, 32
        return {
            "x": _w((lambda *s: torch.randn(*s, dtype=torch.bfloat16) * 0.05)(B, S, D)),
            "wqkv": _w((lambda *s: torch.randn(*s, dtype=torch.bfloat16) * 0.8)(D, 3 * D)),
            "wo": _w((lambda *s: torch.randn(*s, dtype=torch.bfloat16) * 0.05)(D, D)),
        }
    _A_in = _A_setup()

    def _B_setup():
        B, S, D, H = 1, 2048, 576, 32
        return {
            "x": _w((lambda *s: torch.randn(*s, dtype=torch.bfloat16) * 0.05)(B, S, D)),
            "wqkv": _w((lambda *s: torch.randn(*s, dtype=torch.bfloat16) * 0.8)(D, 3 * D)),
            "wo": _w((lambda *s: torch.randn(*s, dtype=torch.bfloat16) * 0.05)(D, D)),
        }
    _B_in = _B_setup()

    return {
        "A_x": _A_in["x"],
        "A_wqkv": _A_in["wqkv"],
        "A_wo": _A_in["wo"],
        "B_x": _B_in["x"],
        "B_wqkv": _B_in["wqkv"],
        "B_wo": _B_in["wo"],
        "gate_w": _w((lambda *s: torch.randn(*s, dtype=torch.bfloat16) * 0.05)(576) * 16.0),
    }

def reference(A_x, A_wqkv, A_wo, B_x, B_wqkv, B_wo, gate_w):
    def _A_ref(x, wqkv, wo):
        B, S, D = x.shape
        H = 32
        Dh = D // H
        qkv = (lambda x, *d: x.permute(*d))((x @ wqkv).reshape(B, S, 3, H, Dh), 2, 0, 3, 1, 4)
        q, k, v = qkv[0], qkv[1], qkv[2]
        scores = torch.einsum("bhqd,bhkd->bhqk", q, k) * (Dh ** -0.5)
        p = _softmax(scores, axis=-1)
        o = torch.einsum("bhqk,bhkd->bhqd", p, v)
        return (lambda x, *d: x.permute(*d))(o, 0, 2, 1, 3).reshape(B, S, D) @ wo

    def _B_ref(x, wqkv, wo):
        B, S, D = x.shape
        H = 32
        Dh = D // H
        qkv = (lambda x, *d: x.permute(*d))((x @ wqkv).reshape(B, S, 3, H, Dh), 2, 0, 3, 1, 4)
        q, k, v = qkv[0], qkv[1], qkv[2]
        scores = torch.einsum("bhqd,bhkd->bhqk", q, k) * (Dh ** -0.5)
        p = _softmax(scores, axis=-1)
        o = torch.einsum("bhqk,bhkd->bhqd", p, v)
        return (lambda x, *d: x.permute(*d))(o, 0, 2, 1, 3).reshape(B, S, D) @ wo

    x = A_x
    g = _sigmoid((x * gate_w).sum(-1, keepdims=True))
    a = _A_ref(x, A_wqkv, A_wo)
    b = _B_ref(x, B_wqkv, B_wo)
    return g * a + (1 - g) * b
```

```asm
; @launch grid=(256,1,1) block=(768,1,1) lds=163840
.amdgcn_target "amdgcn-amd-amdhsa--gfx950"
.text
.globl gated_mix__mha_block__mha_block__prompt_kernel
.p2align 8
.type gated_mix__mha_block__mha_block__prompt_kernel,@function
gated_mix__mha_block__mha_block__prompt_kernel:
    s_cmp_ge_u32 s2, 256
    s_cbranch_scc1 L_done
    s_load_dwordx2 s[4:5], s[0:1], 0
    s_bitcmp1_b32 s2, 2
    s_cselect_b32 s32, 32, 8
    s_load_dwordx2 s[8:9], s[0:1], s32
    s_load_dwordx2 s[16:17], s[0:1], 48
    s_load_dwordx2 s[52:53], s[0:1], 64
    s_load_dwordx2 s[12:13], s[0:1], 72
    s_getpc_b64 s[30:31]
    v_subrev_u32 v10, 256, v0
    v_lshlrev_b32 v10, 7, v10
    v_cmp_gt_u32 vcc, L_done - gated_mix__mha_block__mha_block__prompt_kernel - 64, v10
    s_and_saveexec_b64 s[32:33], vcc
    s_cbranch_execz L_cpf
    global_load_dword v7, v10, s[30:31]
L_cpf:
    s_mov_b64 exec, -1
    v_lshrrev_b32 v10, 6, v0
    v_and_b32 v1, 63, v0
    s_bfe_u32 s22, s2, 0x30003
    v_readfirstlane_b32 s23, v10
    s_and_b32 s21, s2, 7
    s_lshl_b32 s21, s21, 2
    s_lshr_b32 s33, s2, 6
    s_add_u32 s21, s21, s33
    s_mov_b32 s6, 2359296
    s_mov_b32 s7, 0x00020000
    s_mov_b32 s11, s7
    s_mov_b32 s19, s7
    s_mov_b32 s55, s7
    s_mov_b32 s15, s7
    s_cmp_lt_u32 s23, 4
    s_cbranch_scc0 L_compute
    v_lshrrev_b32 v12, 3, v1
    v_mul_u32_u24 v12, 1152, v12
    v_lshrrev_b32 v13, 4, v1
    v_and_b32 v14, 7, v1
    v_xor_b32 v14, v14, v13
    v_lshl_add_u32 v3, v14, 4, v12
    v_xor_b32 v14, 4, v14
    v_lshl_add_u32 v4, v14, 4, v12
    v_add_u32 v4, 8192, v4
    s_lshl_b32 s32, s22, 2
    s_add_u32 s32, s32, s23
    s_mul_i32 s26, s32, 73728
    s_lshl_b32 s28, s23, 13
    v_lshlrev_b32 v14, 2, v13
    v_xor_b32 v14, v14, v1
    v_and_b32 v14, 15, v14
    s_mov_b32 s30, 0x75752020
    s_mov_b32 s31, 0x7446420
    s_mov_b32 s32, 0x21aa0505
    v_mul_u32_u24 v18, 3, v13
    v_lshlrev_b32 v15, 2, v14
    v_lshrrev_b64 v[16:17], v15, s[30:31]
    v_lshlrev_b32 v19, 1, v14
    v_lshrrev_b32 v19, v19, s32
    v_and_b32 v16, 15, v16
    v_and_b32 v19, 3, v19
    v_add_u32 v19, v19, v18
    v_mul_u32_u24 v19, 1152, v19
    v_lshl_add_u32 v5, v16, 3, v19
    v_xor_b32 v15, 8, v15
    v_lshrrev_b64 v[16:17], v15, s[30:31]
    v_lshrrev_b32 v19, 1, v15
    v_lshrrev_b32 v19, v19, s32
    v_and_b32 v16, 15, v16
    v_and_b32 v19, 3, v19
    v_add_u32 v19, v19, v18
    v_mul_u32_u24 v19, 1152, v19
    v_lshl_add_u32 v21, v16, 3, v19
    s_and_b32 s32, s21, 15
    s_mul_i32 s32, s32, 72
    s_mul_i32 s27, s23, 55296
    s_add_u32 s27, s27, s32
    s_lshl_b32 s29, s23, 12
    s_mov_b32 s34, 0xf7ff7fff
    s_mov_b32 s35, 0xfff7ff7f
    s_lshr_b64 s[70:71], s[34:35], 2
    s_or_b32 s71, s71, 0xc0000000
    s_mov_b32 s10, 1990656
    s_waitcnt lgkmcnt(0)
    s_setprio 3
    s_add_u32 m0, s28, 0
    s_add_u32 s32, s26, 0
    buffer_load_dwordx4 v3, s[4:7], s32 offen lds
    buffer_load_dwordx4 v4, s[4:7], s32 offen offset:1024 lds
    s_addk_i32 m0, 0x800
    s_addk_i32 s32, 18432
    buffer_load_dwordx4 v3, s[4:7], s32 offen lds
    buffer_load_dwordx4 v4, s[4:7], s32 offen offset:1024 lds
    s_addk_i32 m0, 0x800
    s_addk_i32 s32, 18432
    buffer_load_dwordx4 v3, s[4:7], s32 offen lds
    buffer_load_dwordx4 v4, s[4:7], s32 offen offset:1024 lds
    s_addk_i32 m0, 0x800
    s_addk_i32 s32, 18432
    buffer_load_dwordx4 v3, s[4:7], s32 offen lds
    buffer_load_dwordx4 v4, s[4:7], s32 offen offset:1024 lds
    s_add_u32 m0, s29, 32768
    s_add_u32 s32, s27, 0
    s_mov_b64 exec, s[34:35]
    buffer_load_dwordx4 v5, s[8:11], s32 offen offset:0 lds
    s_addk_i32 s32, 12800
    buffer_load_dwordx4 v5, s[8:11], s32 offen offset:1024 lds
    s_addk_i32 s32, 12800
    s_mov_b64 exec, s[70:71]
    buffer_load_dwordx4 v21, s[8:11], s32 offen offset:2048 lds
    s_addk_i32 s32, 12800
    buffer_load_dwordx4 v21, s[8:11], s32 offen offset:3072 lds
    s_mov_b64 exec, -1
    s_mov_b32 s10, 1990656
    s_movk_i32 s18, 1152
    s_movk_i32 s54, 256
    s_mov_b32 s14, 16777216
    v_lshlrev_b32 v2, 4, v1
    s_mul_i32 s36, s21, 311296
    s_mul_i32 s67, s23, 43
    s_lshr_b32 s67, s67, 7
    s_mul_i32 s32, s67, 3
    s_sub_u32 s66, s23, s32
    s_mov_b32 s63, 524288
    v_lshlrev_b32 v12, 1, v1
    s_lshl_b32 s32, s23, 7
    buffer_load_ushort v6, v12, s[16:19], s32 offen
    buffer_load_ushort v7, v12, s[16:19], s32 offen offset:512
    buffer_load_ushort v8, v12, s[16:19], s32 offen offset:1024
    v_and_b32 v14, 3, v1
    v_xor_b32 v14, 3, v14
    v_lshlrev_b32 v14, 6, v14
    v_lshl_add_u32 v9, v1, 8, v14
    v_add_u32 v9, 32816, v9
    v_and_b32 v14, 8, v1
    v_lshlrev_b32 v14, 2, v14
    v_xor_b32 v9, v9, v14
    s_cmp_eq_u32 s23, 0
    s_cbranch_scc0 L_e1
    v_and_b32 v17, 1, v1
    v_bfe_u32 v16, v1, 1, 3
    v_mul_u32_u24 v16, 1152, v16
    v_lshl_add_u32 v17, v17, 7, v16
    s_mul_i32 s32, s2, 9216
    s_mov_b64 exec, 0xffff
    buffer_load_dword v18, v17, s[4:7], s32 offen offset:256
    s_branch L_e4
L_e1:
    s_cmp_eq_u32 s23, 1
    s_cbranch_scc0 L_e2
    v_lshlrev_b32 v17, 7, v1
    s_and_b32 s32, s21, 15
    s_lshl_b32 s32, s32, 3
    s_add_u32 s32, s32, s22
    s_mul_i32 s32, s32, 3456
    s_add_u32 s32, s32, 442368
    s_mov_b64 exec, 0x7ffffff
    buffer_load_dword v18, v17, s[8:11], s32 offen
    s_branch L_e4
L_e2:
    s_mov_b64 exec, 1
    buffer_load_ushort v18, v12, s[16:19], 0 offen
L_e4:
    s_mov_b64 exec, -1
    s_add_u32 m0, s28, 49152
    s_add_u32 s32, s26, 128
    buffer_load_dwordx4 v3, s[4:7], s32 offen lds
    buffer_load_dwordx4 v4, s[4:7], s32 offen offset:1024 lds
    s_addk_i32 m0, 0x800
    s_addk_i32 s32, 18432
    buffer_load_dwordx4 v3, s[4:7], s32 offen lds
    buffer_load_dwordx4 v4, s[4:7], s32 offen offset:1024 lds
    s_addk_i32 m0, 0x800
    s_addk_i32 s32, 18432
    buffer_load_dwordx4 v3, s[4:7], s32 offen lds
    buffer_load_dwordx4 v4, s[4:7], s32 offen offset:1024 lds
    s_addk_i32 m0, 0x800
    s_addk_i32 s32, 18432
    buffer_load_dwordx4 v3, s[4:7], s32 offen lds
    buffer_load_dwordx4 v4, s[4:7], s32 offen offset:1024 lds
    s_add_u32 m0, s29, 81920
    s_add_u32 s32, s27, 221184
    s_mov_b64 exec, s[34:35]
    buffer_load_dwordx4 v5, s[8:11], s32 offen offset:0 lds
    s_addk_i32 s32, 12800
    buffer_load_dwordx4 v5, s[8:11], s32 offen offset:1024 lds
    s_addk_i32 s32, 12800
    s_mov_b64 exec, s[70:71]
    buffer_load_dwordx4 v21, s[8:11], s32 offen offset:2048 lds
    s_addk_i32 s32, 12800
    buffer_load_dwordx4 v21, s[8:11], s32 offen offset:3072 lds
    s_mov_b64 exec, -1
    v_lshlrev_b32 v14, 2, v1
    v_add_u32 v14, 162816, v14
    v_mov_b32 v32, 0
    v_mov_b32 v33, 0
    v_mov_b32 v34, 0
    v_mov_b32 v35, 0
    ds_write_b32 v14, v32
    s_min_u32 s32, s23, 2
    s_mul_i32 s32, s32, 49152
    v_add_u32 v14, s32, v9
    s_cmp_eq_u32 s23, 3
    s_cbranch_scc1 L_nz
    ds_write_b128 v14, v[32:35]
L_nz:
    s_waitcnt vmcnt(13)
    s_cmp_eq_u32 s23, 0
    s_cbranch_scc0 L_gw_1
    ds_write_b16 v9, v6 offset:8
L_gw_1:
    s_cmp_eq_u32 s23, 1
    s_cbranch_scc0 L_gw_2
    ds_write_b16 v9, v6 offset:49160
L_gw_2:
    s_cmp_eq_u32 s23, 2
    s_cbranch_scc0 L_gw_3
    v_add_u32 v19, 98304, v9
    ds_write_b16 v19, v6 offset:8
L_gw_3:
    s_waitcnt lgkmcnt(0)
    s_barrier
    s_add_u32 m0, s28, 98304
    s_add_u32 s32, s26, 256
    buffer_load_dwordx4 v3, s[4:7], s32 offen lds
    buffer_load_dwordx4 v4, s[4:7], s32 offen offset:1024 lds
    s_addk_i32 m0, 0x800
    s_addk_i32 s32, 18432
    buffer_load_dwordx4 v3, s[4:7], s32 offen lds
    buffer_load_dwordx4 v4, s[4:7], s32 offen offset:1024 lds
    s_addk_i32 m0, 0x800
    s_addk_i32 s32, 18432
    buffer_load_dwordx4 v3, s[4:7], s32 offen lds
    buffer_load_dwordx4 v4, s[4:7], s32 offen offset:1024 lds
    s_addk_i32 m0, 0x800
    s_addk_i32 s32, 18432
    buffer_load_dwordx4 v3, s[4:7], s32 offen lds
    buffer_load_dwordx4 v4, s[4:7], s32 offen offset:1024 lds
    s_add_u32 m0, s29, 131072
    s_add_u32 s32, s27, 442368
    s_mov_b64 exec, s[34:35]
    buffer_load_dwordx4 v5, s[8:11], s32 offen offset:0 lds
    s_addk_i32 s32, 12800
    buffer_load_dwordx4 v5, s[8:11], s32 offen offset:1024 lds
    s_addk_i32 s32, 12800
    s_mov_b64 exec, s[70:71]
    buffer_load_dwordx4 v21, s[8:11], s32 offen offset:2048 lds
    s_addk_i32 s32, 12800
    buffer_load_dwordx4 v21, s[8:11], s32 offen offset:3072 lds
    s_mov_b64 exec, -1
    s_cmp_eq_u32 s23, 0
    s_cbranch_scc0 L_lp1
    v_and_b32 v17, 7, v1
    v_min_u32 v17, 4, v17
    v_lshrrev_b32 v16, 3, v1
    v_mul_u32_u24 v16, 1152, v16
    v_lshl_add_u32 v17, v17, 7, v16
    s_mul_i32 s32, s2, 9216
    buffer_load_dword v18, v17, s[4:7], s32 offen offset:512
    s_branch L_lp2
L_lp1:
    v_min_u32 v17, 23, v1
    v_lshlrev_b32 v17, 7, v17
    s_and_b32 s32, s21, 15
    s_lshl_b32 s32, s32, 3
    s_add_u32 s32, s32, s22
    s_mul_i32 s32, s32, 3
    s_add_u32 s32, s32, s23
    s_mul_i32 s32, s32, 2880
    s_add_u32 s32, s32, 881856
    buffer_load_dword v18, v17, s[8:11], s32 offen
L_lp2:
    s_lshl_b32 s32, s21, 12
    s_add_u32 s32, s32, 10485760
    v_lshlrev_b32 v24, 7, v1
    v_add_u32 v24, s32, v24
    v_and_b32 v25, 7, v1
    v_lshlrev_b32 v25, 12, v25
    s_lshl_b32 s32, s21, 7
    s_add_u32 s32, s32, 10616832
    v_cmp_gt_u32 vcc, 32, v1
    v_add_u32 v25, s32, v25
    s_cmp_eq_u32 s23, 3
    v_cndmask_b32 v24, v25, v24, vcc
    s_cselect_b32 exec_lo, -1, 1
    s_cselect_b32 exec_hi, 0xff, 0
    buffer_load_dword v25, v24, s[12:15], 0 offen sc1
    s_mov_b64 exec, -1
    s_waitcnt vmcnt(14) lgkmcnt(0)
    s_barrier
    s_cmp_eq_u32 s23, 3
    s_cbranch_scc0 L_gw_4
    ds_write_b16 v9, v6 offset:8
L_gw_4:
    s_add_u32 m0, s28, 0
    s_add_u32 s32, s26, 384
    buffer_load_dwordx4 v3, s[4:7], s32 offen lds
    buffer_load_dwordx4 v4, s[4:7], s32 offen offset:1024 lds
    s_addk_i32 m0, 0x800
    s_addk_i32 s32, 18432
    buffer_load_dwordx4 v3, s[4:7], s32 offen lds
    buffer_load_dwordx4 v4, s[4:7], s32 offen offset:1024 lds
    s_addk_i32 m0, 0x800
    s_addk_i32 s32, 18432
    buffer_load_dwordx4 v3, s[4:7], s32 offen lds
    buffer_load_dwordx4 v4, s[4:7], s32 offen offset:1024 lds
    s_addk_i32 m0, 0x800
    s_addk_i32 s32, 18432
    buffer_load_dwordx4 v3, s[4:7], s32 offen lds
    buffer_load_dwordx4 v4, s[4:7], s32 offen offset:1024 lds
    s_add_u32 m0, s29, 32768
    s_add_u32 s32, s27, 663552
    s_mov_b64 exec, s[34:35]
    buffer_load_dwordx4 v5, s[8:11], s32 offen offset:0 lds
    s_addk_i32 s32, 12800
    buffer_load_dwordx4 v5, s[8:11], s32 offen offset:1024 lds
    s_addk_i32 s32, 12800
    s_mov_b64 exec, s[70:71]
    buffer_load_dwordx4 v21, s[8:11], s32 offen offset:2048 lds
    s_addk_i32 s32, 12800
    buffer_load_dwordx4 v21, s[8:11], s32 offen offset:3072 lds
    s_mov_b64 exec, -1
    s_waitcnt vmcnt(14) lgkmcnt(0)
    s_barrier
    s_cmp_eq_u32 s23, 0
    s_cbranch_scc0 L_gw_5
    ds_write_b16 v9, v7 offset:49160
L_gw_5:
    s_add_u32 m0, s28, 49152
    s_add_u32 s32, s26, 512
    buffer_load_dwordx4 v3, s[4:7], s32 offen lds
    buffer_load_dwordx4 v4, s[4:7], s32 offen offset:1024 lds
    s_addk_i32 m0, 0x800
    s_addk_i32 s32, 18432
    buffer_load_dwordx4 v3, s[4:7], s32 offen lds
    buffer_load_dwordx4 v4, s[4:7], s32 offen offset:1024 lds
    s_addk_i32 m0, 0x800
    s_addk_i32 s32, 18432
    buffer_load_dwordx4 v3, s[4:7], s32 offen lds
    buffer_load_dwordx4 v4, s[4:7], s32 offen offset:1024 lds
    s_addk_i32 m0, 0x800
    s_addk_i32 s32, 18432
    buffer_load_dwordx4 v3, s[4:7], s32 offen lds
    buffer_load_dwordx4 v4, s[4:7], s32 offen offset:1024 lds
    s_add_u32 m0, s29, 81920
    s_add_u32 s32, s27, 884736
    s_mov_b64 exec, s[34:35]
    buffer_load_dwordx4 v5, s[8:11], s32 offen offset:0 lds
    s_addk_i32 s32, 12800
    buffer_load_dwordx4 v5, s[8:11], s32 offen offset:1024 lds
    s_addk_i32 s32, 12800
    s_mov_b64 exec, s[70:71]
    buffer_load_dwordx4 v21, s[8:11], s32 offen offset:2048 lds
    s_addk_i32 s32, 12800
    buffer_load_dwordx4 v21, s[8:11], s32 offen offset:3072 lds
    s_mov_b64 exec, -1
    s_waitcnt vmcnt(12) lgkmcnt(0)
    s_barrier
    s_cmp_eq_u32 s23, 1
    s_cbranch_scc0 L_gw_6
    v_add_u32 v19, 98304, v9
    ds_write_b16 v19, v7 offset:8
L_gw_6:
    s_add_u32 m0, s28, 98304
    s_add_u32 s32, s26, 640
    buffer_load_dwordx4 v3, s[4:7], s32 offen lds
    buffer_load_dwordx4 v4, s[4:7], s32 offen offset:1024 lds
    s_addk_i32 m0, 0x800
    s_addk_i32 s32, 18432
    buffer_load_dwordx4 v3, s[4:7], s32 offen lds
    buffer_load_dwordx4 v4, s[4:7], s32 offen offset:1024 lds
    s_addk_i32 m0, 0x800
    s_addk_i32 s32, 18432
    buffer_load_dwordx4 v3, s[4:7], s32 offen lds
    buffer_load_dwordx4 v4, s[4:7], s32 offen offset:1024 lds
    s_addk_i32 m0, 0x800
    s_addk_i32 s32, 18432
    buffer_load_dwordx4 v3, s[4:7], s32 offen lds
    buffer_load_dwordx4 v4, s[4:7], s32 offen offset:1024 lds
    s_add_u32 m0, s29, 131072
    s_add_u32 s32, s27, 1105920
    s_mov_b64 exec, s[34:35]
    buffer_load_dwordx4 v5, s[8:11], s32 offen offset:0 lds
    s_addk_i32 s32, 12800
    buffer_load_dwordx4 v5, s[8:11], s32 offen offset:1024 lds
    s_addk_i32 s32, 12800
    s_mov_b64 exec, s[70:71]
    buffer_load_dwordx4 v21, s[8:11], s32 offen offset:2048 lds
    s_addk_i32 s32, 12800
    buffer_load_dwordx4 v21, s[8:11], s32 offen offset:3072 lds
    s_mov_b64 exec, -1
    s_waitcnt vmcnt(12) lgkmcnt(0)
    s_barrier
    s_cmp_eq_u32 s23, 2
    s_cbranch_scc0 L_gw_7
    ds_write_b16 v9, v7 offset:8
L_gw_7:
    s_add_u32 m0, s28, 0
    s_add_u32 s32, s26, 768
    buffer_load_dwordx4 v3, s[4:7], s32 offen lds
    buffer_load_dwordx4 v4, s[4:7], s32 offen offset:1024 lds
    s_addk_i32 m0, 0x800
    s_addk_i32 s32, 18432
    buffer_load_dwordx4 v3, s[4:7], s32 offen lds
    buffer_load_dwordx4 v4, s[4:7], s32 offen offset:1024 lds
    s_addk_i32 m0, 0x800
    s_addk_i32 s32, 18432
    buffer_load_dwordx4 v3, s[4:7], s32 offen lds
    buffer_load_dwordx4 v4, s[4:7], s32 offen offset:1024 lds
    s_addk_i32 m0, 0x800
    s_addk_i32 s32, 18432
    buffer_load_dwordx4 v3, s[4:7], s32 offen lds
    buffer_load_dwordx4 v4, s[4:7], s32 offen offset:1024 lds
    s_add_u32 m0, s29, 32768
    s_add_u32 s32, s27, 1327104
    s_mov_b64 exec, s[34:35]
    buffer_load_dwordx4 v5, s[8:11], s32 offen offset:0 lds
    s_addk_i32 s32, 12800
    buffer_load_dwordx4 v5, s[8:11], s32 offen offset:1024 lds
    s_addk_i32 s32, 12800
    s_mov_b64 exec, s[70:71]
    buffer_load_dwordx4 v21, s[8:11], s32 offen offset:2048 lds
    s_addk_i32 s32, 12800
    buffer_load_dwordx4 v21, s[8:11], s32 offen offset:3072 lds
    s_mov_b64 exec, -1
    s_waitcnt vmcnt(12) lgkmcnt(0)
    s_barrier
    s_cmp_eq_u32 s23, 3
    s_cbranch_scc0 L_gw_8
    ds_write_b16 v9, v7 offset:49160
L_gw_8:
    s_add_u32 m0, s28, 49152
    s_add_u32 s32, s26, 896
    buffer_load_dwordx4 v3, s[4:7], s32 offen lds
    buffer_load_dwordx4 v4, s[4:7], s32 offen offset:1024 lds
    s_addk_i32 m0, 0x800
    s_addk_i32 s32, 18432
    buffer_load_dwordx4 v3, s[4:7], s32 offen lds
    buffer_load_dwordx4 v4, s[4:7], s32 offen offset:1024 lds
    s_addk_i32 m0, 0x800
    s_addk_i32 s32, 18432
    buffer_load_dwordx4 v3, s[4:7], s32 offen lds
    buffer_load_dwordx4 v4, s[4:7], s32 offen offset:1024 lds
    s_addk_i32 m0, 0x800
    s_addk_i32 s32, 18432
    buffer_load_dwordx4 v3, s[4:7], s32 offen lds
    buffer_load_dwordx4 v4, s[4:7], s32 offen offset:1024 lds
    s_add_u32 m0, s29, 81920
    s_add_u32 s32, s27, 1548288
    s_mov_b64 exec, s[34:35]
    buffer_load_dwordx4 v5, s[8:11], s32 offen offset:0 lds
    s_addk_i32 s32, 12800
    buffer_load_dwordx4 v5, s[8:11], s32 offen offset:1024 lds
    s_addk_i32 s32, 12800
    s_mov_b64 exec, s[70:71]
    buffer_load_dwordx4 v21, s[8:11], s32 offen offset:2048 lds
    s_addk_i32 s32, 12800
    buffer_load_dwordx4 v21, s[8:11], s32 offen offset:3072 lds
    s_mov_b64 exec, -1
    s_waitcnt vmcnt(12) lgkmcnt(0)
    s_barrier
    s_cmp_eq_u32 s23, 0
    s_cbranch_scc0 L_gw_9
    v_add_u32 v19, 98304, v9
    ds_write_b16 v19, v8 offset:8
L_gw_9:
    s_add_u32 m0, s28, 98304
    s_add_u32 s32, s26, 1024
    buffer_load_dwordx4 v3, s[4:7], s32 offen lds
    buffer_load_dwordx4 v4, s[4:7], s32 offen offset:1024 lds
    s_addk_i32 m0, 0x800
    s_addk_i32 s32, 18432
    buffer_load_dwordx4 v3, s[4:7], s32 offen lds
    buffer_load_dwordx4 v4, s[4:7], s32 offen offset:1024 lds
    s_addk_i32 m0, 0x800
    s_addk_i32 s32, 18432
    buffer_load_dwordx4 v3, s[4:7], s32 offen lds
    buffer_load_dwordx4 v4, s[4:7], s32 offen offset:1024 lds
    s_addk_i32 m0, 0x800
    s_addk_i32 s32, 18432
    buffer_load_dwordx4 v3, s[4:7], s32 offen lds
    buffer_load_dwordx4 v4, s[4:7], s32 offen offset:1024 lds
    s_add_u32 m0, s29, 131072
    s_add_u32 s32, s27, 1769472
    s_mov_b64 exec, s[34:35]
    buffer_load_dwordx4 v5, s[8:11], s32 offen offset:0 lds
    s_addk_i32 s32, 12800
    buffer_load_dwordx4 v5, s[8:11], s32 offen offset:1024 lds
    s_addk_i32 s32, 12800
    s_mov_b64 exec, s[70:71]
    buffer_load_dwordx4 v21, s[8:11], s32 offen offset:2048 lds
    s_addk_i32 s32, 12800
    buffer_load_dwordx4 v21, s[8:11], s32 offen offset:3072 lds
    s_mov_b64 exec, -1
    s_brev_b32 s30, 1
    s_movk_i32 s31, 0x400
    s_cmp_eq_u32 s23, 3
    s_cbranch_scc0 L_nn1
    s_mov_b32 s44, -1
    s_movk_i32 s45, 0xff
    v_and_b32 v24, 1, v25
    v_cmp_ne_u32 vcc, 0, v24
    s_nop 0
    s_and_b64 s[46:47], s[44:45], vcc
    s_andn2_b64 s[44:45], s[44:45], vcc
    s_bcnt1_i32_b64 s32, s[46:47]
    s_bcnt1_i32_b64 s33, s[44:45]
    s_cmp_lt_u32 s32, s33
    s_cselect_b64 s[44:45], s[46:47], s[44:45]
    s_cselect_b32 s32, 1, 0
    s_or_b32 s30, s30, s32
    v_and_b32 v24, 2, v25
    v_cmp_ne_u32 vcc, 0, v24
    s_nop 0
    s_and_b64 s[46:47], s[44:45], vcc
    s_andn2_b64 s[44:45], s[44:45], vcc
    s_bcnt1_i32_b64 s32, s[46:47]
    s_bcnt1_i32_b64 s33, s[44:45]
    s_cmp_lt_u32 s32, s33
    s_cselect_b64 s[44:45], s[46:47], s[44:45]
    s_cselect_b32 s32, 2, 0
    s_or_b32 s30, s30, s32
    v_and_b32 v24, 4, v25
    v_cmp_ne_u32 vcc, 0, v24
    s_nop 0
    s_and_b64 s[46:47], s[44:45], vcc
    s_andn2_b64 s[44:45], s[44:45], vcc
    s_bcnt1_i32_b64 s32, s[46:47]
    s_bcnt1_i32_b64 s33, s[44:45]
    s_cmp_lt_u32 s32, s33
    s_cselect_b64 s[44:45], s[46:47], s[44:45]
    s_cselect_b32 s32, 4, 0
    s_or_b32 s30, s30, s32
    v_and_b32 v24, 8, v25
    v_cmp_ne_u32 vcc, 0, v24
    s_nop 0
    s_and_b64 s[46:47], s[44:45], vcc
    s_andn2_b64 s[44:45], s[44:45], vcc
    s_bcnt1_i32_b64 s32, s[46:47]
    s_bcnt1_i32_b64 s33, s[44:45]
    s_cmp_lt_u32 s32, s33
    s_cselect_b64 s[44:45], s[46:47], s[44:45]
    s_cselect_b32 s32, 8, 0
    s_or_b32 s30, s30, s32
    v_and_b32 v24, 16, v25
    v_cmp_ne_u32 vcc, 0, v24
    s_nop 0
    s_and_b64 s[46:47], s[44:45], vcc
    s_andn2_b64 s[44:45], s[44:45], vcc
    s_bcnt1_i32_b64 s32, s[46:47]
    s_bcnt1_i32_b64 s33, s[44:45]
    s_cmp_lt_u32 s32, s33
    s_cselect_b64 s[44:45], s[46:47], s[44:45]
    s_cselect_b32 s32, 16, 0
    s_or_b32 s30, s30, s32
    v_and_b32 v24, 32, v25
    v_cmp_ne_u32 vcc, 0, v24
    s_nop 0
    s_and_b64 s[46:47], s[44:45], vcc
    s_andn2_b64 s[44:45], s[44:45], vcc
    s_bcnt1_i32_b64 s32, s[46:47]
    s_bcnt1_i32_b64 s33, s[44:45]
    s_cmp_lt_u32 s32, s33
    s_cselect_b64 s[44:45], s[46:47], s[44:45]
    s_cselect_b32 s32, 32, 0
    s_or_b32 s30, s30, s32
    s_lshl_b32 s31, s21, 2
L_nn1:
    v_mov_b32 v24, s30
    v_mov_b32 v25, 0
    v_mov_b32 v26, s30
    v_mov_b32 v27, s31
    s_mov_b64 exec, 1
    buffer_atomic_cmpswap v[24:25], v27, s[52:55], 0 offen sc0 sc1
    s_mov_b64 exec, -1
    s_waitcnt vmcnt(13) lgkmcnt(0)
    s_barrier
    s_cmp_ge_u32 s23, 2
    s_cbranch_scc1 L_cr_10
    s_cmp_eq_u32 s23, 0
    s_cselect_b32 s32, 0x3f803f80, 0
    s_cselect_b32 s33, 224, 0
    s_add_u32 s33, s33, 2624
    v_and_b32 v12, 7, v1
    v_mul_u32_u24 v12, 320, v12
    v_lshrrev_b32 v14, 3, v1
    v_mul_u32_u24 v14, 4608, v14
    v_lshrrev_b32 v15, 4, v1
    v_lshl_add_u32 v14, v15, 9, v14
    v_add3_u32 v12, v12, v14, s33
    v_mov_b32 v32, s32
    v_mov_b32 v33, s32
    v_mov_b32 v34, s32
    v_mov_b32 v35, s32
    ds_write_b128 v12, v[32:35]
L_cr_10:
    s_waitcnt vmcnt(1) lgkmcnt(0)
    s_barrier
    s_load_dwordx2 s[4:5], s[0:1], 16
    s_load_dwordx2 s[8:9], s[0:1], 40
    s_load_dwordx2 s[16:17], s[0:1], 56
    s_mov_b32 s6, 663552
    s_mov_b32 s10, 663552
    s_mov_b32 s18, 2359296
    s_mov_b32 s57, 0
    s_mov_b32 s48, 0x1e400
    s_mov_b32 s49, 0xfffec400
    s_mov_b32 s50, 0xffff5800
    s_mul_i32 s32, s23, 9728
    v_add_u32 v12, s32, v2
    s_add_u32 s36, s36, s32
    s_mov_b32 s28, s32
    s_mul_i32 s30, s22, 38912
    s_add_u32 s30, s30, s36
    s_lshl_b32 s32, s23, 10
    s_lshl_b32 s31, s21, 12
    s_add_u32 s31, s31, s32
    s_add_u32 s27, s31, 10485760
    v_and_b32 v11, 7, v1
    v_lshlrev_b32 v11, 7, v11
    v_mov_b32 v13, 162868
    s_lshl_b32 s32, s22, 7
    v_mov_b32 v14, s32
    v_lshrrev_b32 v15, 3, v1
    v_mul_u32_u24 v15, 1152, v15
    v_bfe_u32 v16, v1, 4, 1
    v_lshlrev_b32 v16, 2, v16
    v_and_b32 v17, 7, v1
    v_xor_b32 v17, v17, v16
    v_lshl_add_u32 v20, v17, 4, v15
    s_waitcnt lgkmcnt(0)
    s_barrier
    ds_read_b128 v[32:35], v12 offset:0
    ds_read_b128 v[36:39], v12 offset:1024
    ds_read_b128 v[40:43], v12 offset:2048
    ds_read_b128 v[44:47], v12 offset:3072
    ds_read_b128 v[48:51], v12 offset:4096
    ds_read_b128 v[52:55], v12 offset:5120
    ds_read_b128 v[56:59], v12 offset:6144
    ds_read_b128 v[60:63], v12 offset:7168
    ds_read_b128 v[64:67], v12 offset:8192
    ds_read_b128 v[68:71], v12 offset:9216
    s_waitcnt lgkmcnt(9)
    buffer_store_dwordx4 v[32:35], v2, s[12:15], s30 offen offset:0 sc1
    s_waitcnt lgkmcnt(8)
    buffer_store_dwordx4 v[36:39], v2, s[12:15], s30 offen offset:1024 sc1
    s_waitcnt lgkmcnt(7)
    buffer_store_dwordx4 v[40:43], v2, s[12:15], s30 offen offset:2048 sc1
    s_waitcnt lgkmcnt(6)
    buffer_store_dwordx4 v[44:47], v2, s[12:15], s30 offen offset:3072 sc1
    s_add_u32 s30, s30, 4096
    s_waitcnt lgkmcnt(5)
    buffer_store_dwordx4 v[48:51], v2, s[12:15], s30 offen offset:0 sc1
    s_waitcnt lgkmcnt(4)
    buffer_store_dwordx4 v[52:55], v2, s[12:15], s30 offen offset:1024 sc1
    s_waitcnt lgkmcnt(3)
    buffer_store_dwordx4 v[56:59], v2, s[12:15], s30 offen offset:2048 sc1
    s_waitcnt lgkmcnt(2)
    buffer_store_dwordx4 v[60:63], v2, s[12:15], s30 offen offset:3072 sc1
    s_add_u32 s30, s30, 4096
    s_waitcnt lgkmcnt(1)
    buffer_store_dwordx4 v[64:67], v2, s[12:15], s30 offen offset:0 sc1
    s_mov_b32 exec_hi, 0
    s_waitcnt lgkmcnt(0)
    buffer_store_dwordx4 v[68:71], v2, s[12:15], s30 offen offset:1024 sc1
    s_mov_b64 exec, 1
    s_cmp_eq_u32 s23, 3
    s_cbranch_scc0 L_nn2
    s_waitcnt vmcnt(10)
    v_cmp_eq_u32 vcc, 0, v24
    s_nop 1
    v_cndmask_b32 v24, v24, v26, vcc
    ds_write_b32 v13, v24
L_nn2:
    ds_read_b32 v10, v13
    s_waitcnt lgkmcnt(0)
    v_cmp_eq_u32 vcc, 0, v10
    s_cbranch_vccnz L_nn2
    v_readfirstlane_b32 s60, v10
    s_waitcnt vmcnt(0)
    buffer_store_dword v10, v14, s[12:15], s27 offen sc1
    s_mov_b64 exec, -1
    s_mov_b32 s61, 0
    s_mov_b32 s38, 0
    s_lshl_b32 s26, 1, s22
L_ll:
    s_add_u32 s28, s28, s48
    s_mov_b32 s32, s48
    s_mov_b32 s48, s49
    s_mov_b32 s49, s50
    s_mov_b32 s50, s32
L_poll:
    s_andn2_b32 s32, s61, s26
    s_cbranch_scc1 L_rdy
    buffer_load_dword v10, v11, s[12:15], s27 offen sc1
    s_waitcnt vmcnt(0)
    v_cmp_eq_u32 vcc, s60, v10
    s_sub_u32 s63, s63, 1
    s_nop 0
    s_cselect_b32 s61, -1, vcc_lo
    s_and_b32 s61, s61, 0xff
    s_branch L_poll
L_rdy:
    s_ff1_i32_b32 s37, s32
    s_bitset1_b32 s26, s37
    s_mul_i32 s30, s37, 38912
    s_add_u32 s30, s30, s36
    s_add_u32 m0, s28, 0
    s_add_u32 s32, s30, 0
    buffer_load_dwordx4 v2, s[12:15], s32 offen offset:0 sc1 lds
    buffer_load_dwordx4 v2, s[12:15], s32 offen offset:1024 sc1 lds
    buffer_load_dwordx4 v2, s[12:15], s32 offen offset:2048 sc1 lds
    buffer_load_dwordx4 v2, s[12:15], s32 offen offset:3072 sc1 lds
    s_add_u32 m0, s28, 4096
    s_add_u32 s32, s30, 4096
    buffer_load_dwordx4 v2, s[12:15], s32 offen offset:0 sc1 lds
    buffer_load_dwordx4 v2, s[12:15], s32 offen offset:1024 sc1 lds
    buffer_load_dwordx4 v2, s[12:15], s32 offen offset:2048 sc1 lds
    buffer_load_dwordx4 v2, s[12:15], s32 offen offset:3072 sc1 lds
    s_add_u32 m0, s28, 8192
    s_add_u32 s32, s30, 8192
    buffer_load_dwordx4 v2, s[12:15], s32 offen offset:0 sc1 lds
    s_mov_b32 exec_hi, 0
    buffer_load_dwordx4 v2, s[12:15], s32 offen offset:1024 sc1 lds
    s_mov_b32 exec_hi, -1
L_d9:
    s_cmp_eq_u32 s38, 1
    s_cbranch_scc0 L_ncl
    s_lshl_b32 s32, s22, 3
    s_lshl_b32 s33, s23, 1
    s_add_u32 s32, s32, s33
    s_mul_i32 s30, s32, 73728
    s_mul_i32 s32, s21, 2304
    s_add_u32 s30, s30, s32
    s_add_u32 s30, s30, 11534336
    s_add_u32 s31, s30, 73728
    v_mov_b32 v32, -1
    v_mov_b32 v33, -1
    v_mov_b32 v34, -1
    v_mov_b32 v35, -1
    buffer_store_dwordx4 v[32:35], v2, s[12:15], s30 offen sc1
    buffer_store_dwordx4 v[32:35], v2, s[12:15], s30 offen offset:1024 sc1
    buffer_store_dwordx4 v[32:35], v2, s[12:15], s31 offen sc1
    buffer_store_dwordx4 v[32:35], v2, s[12:15], s31 offen offset:1024 sc1
    s_mov_b64 exec, 0xffff
    buffer_store_dwordx4 v[32:35], v2, s[12:15], s30 offen offset:2048 sc1
    buffer_store_dwordx4 v[32:35], v2, s[12:15], s31 offen offset:2048 sc1
    s_mov_b64 exec, -1
L_ncl:
    s_cmp_eq_u32 s23, 0
    s_cbranch_scc0 L_nfl
    s_cmp_eq_u32 s38, 2
    s_cbranch_scc0 L_n2
    s_lshl_b32 s32, s22, 12
    s_lshl_b32 s33, s21, 7
    s_add_u32 s32, s32, s33
    s_add_u32 s32, s32, 10616832
    v_mov_b32 v15, 0
    v_mov_b32 v10, s60
    s_mov_b64 exec, 1
    buffer_store_dword v10, v15, s[12:15], s32 offen sc1
    s_mov_b64 exec, -1
L_n2:
    s_cmp_eq_u32 s38, 4
    s_cbranch_scc0 L_nfl
    s_and_b32 s30, s2, 7
    v_and_b32 v17, 7, v1
    v_lshlrev_b32 v16, 2, v17
L_cl:
    s_lshl_b32 s32, s30, 2
    v_mov_b32 v15, s32
    v_mov_b32 v10, 1
    s_mov_b64 exec, 1
    buffer_atomic_add v10, v15, s[52:55], 0 offen offset:128 sc0 sc1
    s_mov_b64 exec, -1
    s_waitcnt vmcnt(0)
    v_readfirstlane_b32 s31, v10
    s_nop 3
    s_cmp_lt_u32 s31, 27
    s_cbranch_scc1 L_cl2
    buffer_load_dword v10, v16, s[52:55], 0 offen offset:128 sc1
    s_waitcnt vmcnt(0)
    v_lshl_or_b32 v10, v10, 3, v17
    s_nop 0
    v_readlane_b32 s30, v10, 0
    v_readlane_b32 s32, v10, 1
    s_nop 3
    s_min_u32 s30, s30, s32
    v_readlane_b32 s32, v10, 2
    s_nop 3
    s_min_u32 s30, s30, s32
    v_readlane_b32 s32, v10, 3
    s_nop 3
    s_min_u32 s30, s30, s32
    v_readlane_b32 s32, v10, 4
    s_nop 3
    s_min_u32 s30, s30, s32
    v_readlane_b32 s32, v10, 5
    s_nop 3
    s_min_u32 s30, s30, s32
    v_readlane_b32 s32, v10, 6
    s_nop 3
    s_min_u32 s30, s30, s32
    v_readlane_b32 s32, v10, 7
    s_nop 3
    s_min_u32 s30, s30, s32
    s_lshr_b32 s32, s30, 3
    s_and_b32 s30, s30, 7
    s_sub_u32 s63, s63, 1
    s_cselect_b32 s32, 27, s32
    s_cmp_lt_u32 s32, 27
    s_cbranch_scc1 L_cl
    s_mov_b32 s63, 524288
    s_movk_i32 s31, 0xff
L_cl2:
    s_lshl_b32 s30, s30, 8
    s_or_b32 s30, s30, s31
    v_mov_b32 v10, s30
    v_mov_b32 v15, 162864
    ds_write_b32 v15, v10
    s_waitcnt lgkmcnt(0)
L_nfl:
    s_cmp_eq_u32 s38, 5
    s_cbranch_scc0 L_nw3
    v_mov_b32 v15, 162864
    ds_read_b32 v10, v15
    s_waitcnt lgkmcnt(0)
    v_readfirstlane_b32 s57, v10
    s_nop 3
    s_lshr_b32 s68, s57, 8
    s_and_b32 s68, s68, 7
    s_and_b32 s57, s57, 0xff
    s_lshr_b32 s64, s57, 1
    s_and_b32 s65, s57, 1
    s_mul_i32 s65, s65, 3
    s_sub_u32 s32, s57, 18
    s_cmp_ge_u32 s57, 18
    s_cselect_b32 s64, s32, s64
    s_cselect_b32 s65, 6, s65
    s_add_u32 s65, s65, s66
    s_lshl_b32 s32, s68, 3
    s_add_u32 s32, s32, s65
    s_mul_i32 s69, s32, 73728
    s_mul_i32 s32, s67, 18432
    s_add_u32 s69, s69, s32
    s_add_u32 s69, s69, 11534336
    s_cmp_ge_u32 s57, 27
    s_cbranch_scc1 L_on1
    s_lshl_b32 s32, s64, 7
    v_add_u32 v20, s32, v20
    s_add_u32 s30, s23, 38
L_wo_11:
    s_lshl_b32 m0, s30, 10
    s_sub_u32 s32, s30, 0
    s_mul_i32 s32, s32, 9216
    buffer_load_dwordx4 v20, s[4:7], s32 offen lds
    s_add_u32 s30, s30, 4
    s_cmp_lt_u32 s30, 42
    s_cbranch_scc1 L_wo_11
    s_add_u32 s30, s23, 80
L_wo_12:
    s_lshl_b32 m0, s30, 10
    s_sub_u32 s32, s30, 72
    s_mul_i32 s32, s32, 9216
    buffer_load_dwordx4 v20, s[8:11], s32 offen lds
    s_add_u32 s30, s30, 4
    s_cmp_lt_u32 s30, 121
    s_cbranch_scc1 L_wo_12
L_nw3:
    s_cmp_eq_u32 s38, 6
    s_cbranch_scc0 L_on1
    s_cmp_ge_u32 s57, 27
    s_cbranch_scc1 L_on1
    v_mul_u32_u24 v15, 1152, v1
    s_lshl_b32 s32, s64, 7
    s_mul_i32 s33, s23, 55296
    s_add_u32 s33, s33, s32
    s_add_u32 s33, s33, 451584
    buffer_load_dword v16, v15, s[8:11], s33 offen
    v_and_b32 v12, 31, v1
    v_lshlrev_b32 v15, 7, v12
    v_lshlrev_b32 v12, 2, v12
    s_lshl_b32 s31, s68, 12
    s_add_u32 s31, s31, 10616832
L_on0:
    buffer_load_dword v10, v12, s[52:55], 0 offen sc1
    buffer_load_dword v16, v15, s[12:15], s31 offen sc1
    s_waitcnt vmcnt(0)
    v_cmp_le_i32 vcc, 0, v10
    v_cmp_ne_u32 s[44:45], v10, v16
    s_sub_u32 s63, s63, 1
    s_cbranch_scc1 L_on1
    s_or_b64 vcc, vcc, s[44:45]
    s_cbranch_vccz L_on1
    s_sleep 8
    s_branch L_on0
L_on1:
    s_waitcnt vmcnt(0)
    s_barrier
    s_add_u32 s38, s38, 1
    s_cmp_lt_u32 s38, 7
    s_cbranch_scc1 L_ll
    s_mov_b32 s63, 524288
    s_cmp_ge_u32 s57, 27
    s_cbranch_scc1 L_end
    s_add_u32 s30, s23, 0
L_wo_13:
    s_lshl_b32 m0, s30, 10
    s_sub_u32 s32, s30, 0
    s_mul_i32 s32, s32, 9216
    buffer_load_dwordx4 v20, s[4:7], s32 offen lds
    s_add_u32 s30, s30, 4
    s_cmp_lt_u32 s30, 38
    s_cbranch_scc1 L_wo_13
    s_add_u32 s30, s23, 42
L_wo_14:
    s_lshl_b32 m0, s30, 10
    s_sub_u32 s32, s30, 0
    s_mul_i32 s32, s32, 9216
    buffer_load_dwordx4 v20, s[4:7], s32 offen lds
    s_add_u32 s30, s30, 4
    s_cmp_lt_u32 s30, 72
    s_cbranch_scc1 L_wo_14
    s_add_u32 s30, s23, 72
L_wo_15:
    s_lshl_b32 m0, s30, 10
    s_sub_u32 s32, s30, 72
    s_mul_i32 s32, s32, 9216
    buffer_load_dwordx4 v20, s[8:11], s32 offen lds
    s_add_u32 s30, s30, 4
    s_cmp_lt_u32 s30, 80
    s_cbranch_scc1 L_wo_15
    v_and_b32 v12, 7, v1
    v_lshlrev_b32 v12, 2, v12
    v_add_u32 v12, 162816, v12
L_pg:
    s_sleep 2
    ds_read_b32 v13, v12
    s_waitcnt lgkmcnt(0)
    v_cmp_gt_u32 vcc, 7, v13
    s_cbranch_vccnz L_pg
    s_add_u32 s30, s23, 121
L_wo_16:
    s_lshl_b32 m0, s30, 10
    s_sub_u32 s32, s30, 72
    s_mul_i32 s32, s32, 9216
    buffer_load_dwordx4 v20, s[8:11], s32 offen lds
    s_add_u32 s30, s30, 4
    s_cmp_lt_u32 s30, 144
    s_cbranch_scc1 L_wo_16
    s_lshl_b32 s32, s23, 2
    s_add_u32 s32, s32, 162848
    v_mov_b32 v12, s32
    v_mov_b32 v13, 8
    s_waitcnt vmcnt(0)
    ds_write_b32 v12, v13
    s_setprio 0
    s_branch L_tail
L_compute:
    s_mov_b32 s10, 1990656
    s_movk_i32 s18, 1152
    s_movk_i32 s54, 256
    s_mov_b32 s14, 16777216
    v_lshlrev_b32 v2, 4, v1
    s_mul_i32 s36, s21, 311296
    s_mul_i32 s67, s23, 43
    s_lshr_b32 s67, s67, 7
    s_mul_i32 s32, s67, 3
    s_sub_u32 s66, s23, s32
    s_mov_b32 s63, 524288
    s_sub_u32 s20, s23, 4
    s_lshr_b32 s24, s20, 2
    s_and_b32 s25, s20, 3
    s_load_dwordx2 s[44:45], s[0:1], 56
    s_mov_b32 s18, 2359296
    s_waitcnt lgkmcnt(0)
    s_mov_b64 s[16:17], s[44:45]
    v_and_b32 v32, 31, v1
    v_lshrrev_b32 v33, 5, v1
    v_and_b32 v41, 15, v1
    v_lshrrev_b32 v42, 4, v1
    s_lshl_b32 s32, s25, 13
    v_lshlrev_b32 v34, 7, v41
    v_add_u32 v34, s32, v34
    v_lshrrev_b32 v35, 1, v41
    v_xor_b32 v35, v35, v42
    v_lshl_add_u32 v16, v35, 4, v34
    v_xor_b32 v17, 64, v16
    v_bfe_u32 v34, v1, 2, 2
    v_lshl_add_u32 v35, v42, 3, v34
    v_lshlrev_b32 v35, 8, v35
    v_add_u32 v35, 32768, v35
    v_and_b32 v36, 3, v1
    v_lshlrev_b32 v36, 3, v36
    v_and_b32 v37, 16, v1
    v_lshlrev_b32 v37, 1, v37
    v_add3_u32 v39, v35, v36, v37
    v_xor_b32 v18, s24, v34
    v_lshl_add_u32 v18, v18, 6, v39
    v_xor_b32 v19, 32, v18
    s_mov_b32 s32, 0x38102800
    s_cmp_eq_u32 s24, 1
    s_cselect_b32 s32, s32, 0x18100800
    v_lshrrev_b32 v38, v36, s32
    v_and_b32 v38, 0xff, v38
    v_xor_b32 v38, v38, v37
    v_add_u32 v39, v35, v38
    s_add_u32 s32, s24, 2
    v_xor_b32 v20, s32, v34
    v_lshl_add_u32 v20, v20, 6, v39
    v_xor_b32 v21, 32, v20
    v_add_u32 v22, 98304, v16
    v_add_u32 v23, 98304, v17
    v_add_u32 v24, 98304, v18
    v_add_u32 v25, 98304, v19
    v_add_u32 v26, 98304, v20
    v_add_u32 v27, 98304, v21
    v_mov_b32 v96, 0
    v_mov_b32 v97, 0
    v_mov_b32 v98, 0
    v_mov_b32 v99, 0
    v_mov_b32 v100, 0
    v_mov_b32 v101, 0
    v_mov_b32 v102, 0
    v_mov_b32 v103, 0
    v_mov_b32 v104, 0
    v_mov_b32 v105, 0
    v_mov_b32 v106, 0
    v_mov_b32 v107, 0
    v_mov_b32 v108, 0
    v_mov_b32 v109, 0
    v_mov_b32 v110, 0
    v_mov_b32 v111, 0
    v_mov_b32 v112, 0
    v_mov_b32 v113, 0
    v_mov_b32 v114, 0
    v_mov_b32 v115, 0
    v_mov_b32 v116, 0
    v_mov_b32 v117, 0
    v_mov_b32 v118, 0
    v_mov_b32 v119, 0
    v_mov_b32 v120, 0
    v_mov_b32 v121, 0
    v_mov_b32 v122, 0
    v_mov_b32 v123, 0
    v_mov_b32 v124, 0
    v_mov_b32 v125, 0
    v_mov_b32 v126, 0
    v_mov_b32 v127, 0
    v_mov_b32 v128, 0
    v_mov_b32 v129, 0
    v_mov_b32 v130, 0
    v_mov_b32 v131, 0
    v_mov_b32 v132, 0
    v_mov_b32 v133, 0
    v_mov_b32 v134, 0
    v_mov_b32 v135, 0
    v_mov_b32 v136, 0
    v_mov_b32 v137, 0
    v_mov_b32 v138, 0
    v_mov_b32 v139, 0
    v_mov_b32 v140, 0
    v_mov_b32 v141, 0
    v_mov_b32 v142, 0
    v_mov_b32 v143, 0
    v_mov_b32 v144, 0
    v_mov_b32 v145, 0
    v_mov_b32 v146, 0
    v_mov_b32 v147, 0
    v_mov_b32 v148, 0
    v_mov_b32 v149, 0
    v_mov_b32 v150, 0
    v_mov_b32 v151, 0
    v_mov_b32 v152, 0
    v_mov_b32 v153, 0
    v_mov_b32 v154, 0
    v_mov_b32 v155, 0
    v_mov_b32 v156, 0
    v_mov_b32 v157, 0
    v_mov_b32 v158, 0
    v_mov_b32 v159, 0
    s_lshl_b32 s32, s24, 10
    s_add_u32 s32, s32, 512
    v_add_u32 v3, s32, v2
    v_lshlrev_b32 v4, 2, v1
    s_lshl_b32 s33, s24, 8
    v_add_u32 v4, s33, v4
    v_mov_b32 v34, 4
    v_cmp_gt_u32 vcc, 19, v32
    v_mov_b32 v35, 19
    s_nop 0
    v_cndmask_b32 v34, v34, v32, vcc
    v_cmp_eq_u32 vcc, 4, v32
    v_mul_u32_u24 v36, 320, v33
    s_mul_i32 s33, s24, 1280
    s_add_u32 s33, s33, 2560
    v_cndmask_b32 v34, v34, v35, vcc
    v_lshl_add_u32 v5, v34, 4, v36
    v_add_u32 v5, s33, v5
    v_mov_b32 v6, 0xdddddddd
    s_lshl_b32 s32, s22, 3
    s_lshl_b32 s33, s25, 1
    s_add_u32 s32, s32, s33
    s_mul_i32 s30, s32, 73728
    s_mul_i32 s32, s21, 2304
    s_add_u32 s30, s30, s32
    s_add_u32 s30, s30, 11534336
    s_lshl_b32 s32, s24, 10
    s_add_u32 s58, s30, s32
    s_lshl_b32 s32, s24, 7
    s_add_u32 s59, s30, s32
    s_mov_b32 s48, 0x1e400
    s_mov_b32 s49, 0xfffec400
    s_mov_b32 s50, 0xffff5800
    s_mov_b32 s70, 0x3eae1a93
    s_mov_b32 s71, 0x3eae1a93
    v_and_b32 v34, 3, v32
    v_and_b32 v35, 12, v32
    v_lshl_or_b32 v34, v35, 1, v34
    v_and_b32 v35, 16, v32
    v_lshrrev_b32 v35, 2, v35
    v_or_b32 v34, v34, v35
    s_lshl_b32 s32, s24, 10
    s_mul_i32 s31, s25, 9728
    s_add_u32 s32, s32, s31
    s_add_u32 s32, s32, 512
    v_lshlrev_b32 v160, 9, v33
    v_lshl_add_u32 v160, v34, 4, v160
    v_add_u32 v160, s32, v160
    s_lshl_b32 s32, s25, 8
    s_add_u32 s32, s32, 38912
    v_lshlrev_b32 v161, 2, v32
    v_add_u32 v161, s32, v161
    s_cmp_eq_u32 s24, 1
    s_cbranch_scc1 L_a1
    v_mul_u32_u24 v36, 320, v42
    s_add_u32 s32, s31, 2560
    v_add_u32 v36, s32, v36
    v_mov_b32 v38, 19
    v_cmp_eq_u32 vcc, 4, v41
    v_add_u32 v35, 16, v41
    v_add_u32 v37, 78, v41
    v_cndmask_b32 v38, v41, v38, vcc
    v_cmp_le_u32 vcc, 2, v41
    v_lshl_add_u32 v162, v38, 4, v36
    v_mov_b32 v38, 99
    v_cndmask_b32 v35, v35, v37, vcc
    v_cmp_eq_u32 vcc, 6, v41
    s_nop 1
    v_cndmask_b32 v35, v35, v38, vcc
    v_lshl_add_u32 v163, v35, 4, v36
    s_branch L_a2
L_a1:
    v_lshlrev_b32 v162, 2, v34
    v_add_u32 v162, s31, v162
    v_cmp_eq_u32 vcc, 1, v33
    v_add_u32 v37, 256, v162
    v_add_u32 v38, 1024, v161
    v_cndmask_b32 v162, v162, v161, vcc
    v_cndmask_b32 v163, v37, v38, vcc
    v_mov_b32 v37, 1.0
    v_mov_b32 v38, s70
    v_cndmask_b32 v164, v37, v38, vcc
    v_lshrrev_b32 v35, 3, v34
    v_mul_u32_u24 v35, 320, v35
    v_and_b32 v37, 7, v34
    v_lshl_add_u32 v165, v37, 1, v35
    s_add_u32 s32, s31, 3840
    v_add_u32 v165, s32, v165
L_a2:
    s_lshl_b32 s32, s24, 10
    v_lshl_add_u32 v166, v33, 7, v161
    v_add_u32 v166, s32, v166
    s_mov_b32 s34, 0x7ffff
    s_mov_b32 s35, 0x7ffff
    s_lshl_b32 s32, s20, 2
    s_add_u32 s32, s32, 162816
    v_mov_b32 v167, s32
    s_waitcnt lgkmcnt(0)
    s_cmp_eq_u32 s20, 7
    s_cbranch_scc0 L_tlb
    s_buffer_load_dword s3, s[12:15], s36
    s_buffer_load_dword s3, s[12:15], s36 offset:0x4bffc
    s_mov_b32 s32, 10682368
    s_buffer_load_dword s3, s[12:15], s32
    s_buffer_load_dword s3, s[52:55], 0xfc
L_tlb:
    s_barrier
    ds_read_b128 v[64:67], v16 offset:0
    ds_read_b64_tr_b16 v[80:81], v18 offset:0
    ds_read_b64_tr_b16 v[82:83], v18 offset:1024
    ds_read_b128 v[68:71], v16 offset:2048
    ds_read_b64_tr_b16 v[84:85], v19 offset:0
    ds_read_b64_tr_b16 v[86:87], v19 offset:1024
    ds_read_b128 v[72:75], v16 offset:4096
    ds_read_b64_tr_b16 v[88:89], v20 offset:0
    ds_read_b64_tr_b16 v[90:91], v20 offset:1024
    ds_read_b128 v[76:79], v16 offset:6144
    ds_read_b64_tr_b16 v[92:93], v21 offset:0
    ds_read_b64_tr_b16 v[94:95], v21 offset:1024
    s_mov_b32 s38, 0
    s_cmp_eq_u32 s24, 1
    s_cbranch_scc1 L_g1
L_g0:
    s_waitcnt lgkmcnt(0)
    ds_read_b128 v[32:35], v17 offset:0
    ds_read_b64_tr_b16 v[48:49], v18 offset:8192
    ds_read_b64_tr_b16 v[50:51], v18 offset:9216
    ds_read_b128 v[36:39], v17 offset:2048
    ds_read_b64_tr_b16 v[52:53], v19 offset:8192
    ds_read_b64_tr_b16 v[54:55], v19 offset:9216
    ds_read_b128 v[40:43], v17 offset:4096
    ds_read_b64_tr_b16 v[56:57], v20 offset:8192
    ds_read_b64_tr_b16 v[58:59], v20 offset:9216
    ds_read_b128 v[44:47], v17 offset:6144
    ds_read_b64_tr_b16 v[60:61], v21 offset:8192
    ds_read_b64_tr_b16 v[62:63], v21 offset:9216
    v_mfma_f32_16x16x32_bf16 v[96:99], v[80:83], v[64:67], v[96:99]
    v_mfma_f32_16x16x32_bf16 v[100:103], v[80:83], v[68:71], v[100:103]
    v_mfma_f32_16x16x32_bf16 v[104:107], v[80:83], v[72:75], v[104:107]
    v_mfma_f32_16x16x32_bf16 v[108:111], v[80:83], v[76:79], v[108:111]
    v_mfma_f32_16x16x32_bf16 v[112:115], v[84:87], v[64:67], v[112:115]
    v_mfma_f32_16x16x32_bf16 v[116:119], v[84:87], v[68:71], v[116:119]
    v_mfma_f32_16x16x32_bf16 v[120:123], v[84:87], v[72:75], v[120:123]
    v_mfma_f32_16x16x32_bf16 v[124:127], v[84:87], v[76:79], v[124:127]
    v_mfma_f32_16x16x32_bf16 v[128:131], v[64:67], v[88:91], v[128:131]
    v_mfma_f32_16x16x32_bf16 v[132:135], v[68:71], v[88:91], v[132:135]
    v_mfma_f32_16x16x32_bf16 v[136:139], v[72:75], v[88:91], v[136:139]
    v_mfma_f32_16x16x32_bf16 v[140:143], v[76:79], v[88:91], v[140:143]
    v_mfma_f32_16x16x32_bf16 v[144:147], v[64:67], v[92:95], v[144:147]
    v_mfma_f32_16x16x32_bf16 v[148:151], v[68:71], v[92:95], v[148:151]
    v_mfma_f32_16x16x32_bf16 v[152:155], v[72:75], v[92:95], v[152:155]
    v_mfma_f32_16x16x32_bf16 v[156:159], v[76:79], v[92:95], v[156:159]
    s_waitcnt lgkmcnt(0)
    s_barrier
    ds_read_b128 v[64:67], v16 offset:49152
    ds_read_b64_tr_b16 v[80:81], v18 offset:49152
    ds_read_b64_tr_b16 v[82:83], v18 offset:50176
    ds_read_b128 v[68:71], v16 offset:51200
    ds_read_b64_tr_b16 v[84:85], v19 offset:49152
    ds_read_b64_tr_b16 v[86:87], v19 offset:50176
    ds_read_b128 v[72:75], v16 offset:53248
    ds_read_b64_tr_b16 v[88:89], v20 offset:49152
    ds_read_b64_tr_b16 v[90:91], v20 offset:50176
    ds_read_b128 v[76:79], v16 offset:55296
    ds_read_b64_tr_b16 v[92:93], v21 offset:49152
    ds_read_b64_tr_b16 v[94:95], v21 offset:50176
    v_mfma_f32_16x16x32_bf16 v[96:99], v[48:51], v[32:35], v[96:99]
    v_mfma_f32_16x16x32_bf16 v[100:103], v[48:51], v[36:39], v[100:103]
    v_mfma_f32_16x16x32_bf16 v[104:107], v[48:51], v[40:43], v[104:107]
    v_mfma_f32_16x16x32_bf16 v[108:111], v[48:51], v[44:47], v[108:111]
    v_mfma_f32_16x16x32_bf16 v[112:115], v[52:55], v[32:35], v[112:115]
    v_mfma_f32_16x16x32_bf16 v[116:119], v[52:55], v[36:39], v[116:119]
    v_mfma_f32_16x16x32_bf16 v[120:123], v[52:55], v[40:43], v[120:123]
    v_mfma_f32_16x16x32_bf16 v[124:127], v[52:55], v[44:47], v[124:127]
    v_mfma_f32_16x16x32_bf16 v[128:131], v[32:35], v[56:59], v[128:131]
    v_mfma_f32_16x16x32_bf16 v[132:135], v[36:39], v[56:59], v[132:135]
    v_mfma_f32_16x16x32_bf16 v[136:139], v[40:43], v[56:59], v[136:139]
    v_mfma_f32_16x16x32_bf16 v[140:143], v[44:47], v[56:59], v[140:143]
    v_mfma_f32_16x16x32_bf16 v[144:147], v[32:35], v[60:63], v[144:147]
    v_mfma_f32_16x16x32_bf16 v[148:151], v[36:39], v[60:63], v[148:151]
    v_mfma_f32_16x16x32_bf16 v[152:155], v[40:43], v[60:63], v[152:155]
    v_mfma_f32_16x16x32_bf16 v[156:159], v[44:47], v[60:63], v[156:159]
    s_waitcnt lgkmcnt(0)
    ds_read_b128 v[32:35], v17 offset:49152
    ds_read_b64_tr_b16 v[48:49], v18 offset:57344
    ds_read_b64_tr_b16 v[50:51], v18 offset:58368
    ds_read_b128 v[36:39], v17 offset:51200
    ds_read_b64_tr_b16 v[52:53], v19 offset:57344
    ds_read_b64_tr_b16 v[54:55], v19 offset:58368
    ds_read_b128 v[40:43], v17 offset:53248
    ds_read_b64_tr_b16 v[56:57], v20 offset:57344
    ds_read_b64_tr_b16 v[58:59], v20 offset:58368
    ds_read_b128 v[44:47], v17 offset:55296
    ds_read_b64_tr_b16 v[60:61], v21 offset:57344
    ds_read_b64_tr_b16 v[62:63], v21 offset:58368
    v_mfma_f32_16x16x32_bf16 v[96:99], v[80:83], v[64:67], v[96:99]
    v_mfma_f32_16x16x32_bf16 v[100:103], v[80:83], v[68:71], v[100:103]
    v_mfma_f32_16x16x32_bf16 v[104:107], v[80:83], v[72:75], v[104:107]
    v_mfma_f32_16x16x32_bf16 v[108:111], v[80:83], v[76:79], v[108:111]
    v_mfma_f32_16x16x32_bf16 v[112:115], v[84:87], v[64:67], v[112:115]
    v_mfma_f32_16x16x32_bf16 v[116:119], v[84:87], v[68:71], v[116:119]
    v_mfma_f32_16x16x32_bf16 v[120:123], v[84:87], v[72:75], v[120:123]
    v_mfma_f32_16x16x32_bf16 v[124:127], v[84:87], v[76:79], v[124:127]
    v_mfma_f32_16x16x32_bf16 v[128:131], v[64:67], v[88:91], v[128:131]
    v_mfma_f32_16x16x32_bf16 v[132:135], v[68:71], v[88:91], v[132:135]
    v_mfma_f32_16x16x32_bf16 v[136:139], v[72:75], v[88:91], v[136:139]
    v_mfma_f32_16x16x32_bf16 v[140:143], v[76:79], v[88:91], v[140:143]
    v_mfma_f32_16x16x32_bf16 v[144:147], v[64:67], v[92:95], v[144:147]
    v_mfma_f32_16x16x32_bf16 v[148:151], v[68:71], v[92:95], v[148:151]
    v_mfma_f32_16x16x32_bf16 v[152:155], v[72:75], v[92:95], v[152:155]
    v_mfma_f32_16x16x32_bf16 v[156:159], v[76:79], v[92:95], v[156:159]
    s_waitcnt lgkmcnt(0)
    s_barrier
    ds_read_b128 v[64:67], v22 offset:0
    ds_read_b64_tr_b16 v[80:81], v24 offset:0
    ds_read_b64_tr_b16 v[82:83], v24 offset:1024
    ds_read_b128 v[68:71], v22 offset:2048
    ds_read_b64_tr_b16 v[84:85], v25 offset:0
    ds_read_b64_tr_b16 v[86:87], v25 offset:1024
    ds_read_b128 v[72:75], v22 offset:4096
    ds_read_b64_tr_b16 v[88:89], v26 offset:0
    ds_read_b64_tr_b16 v[90:91], v26 offset:1024
    ds_read_b128 v[76:79], v22 offset:6144
    ds_read_b64_tr_b16 v[92:93], v27 offset:0
    ds_read_b64_tr_b16 v[94:95], v27 offset:1024
    v_mfma_f32_16x16x32_bf16 v[96:99], v[48:51], v[32:35], v[96:99]
    v_mfma_f32_16x16x32_bf16 v[100:103], v[48:51], v[36:39], v[100:103]
    v_mfma_f32_16x16x32_bf16 v[104:107], v[48:51], v[40:43], v[104:107]
    v_mfma_f32_16x16x32_bf16 v[108:111], v[48:51], v[44:47], v[108:111]
    v_mfma_f32_16x16x32_bf16 v[112:115], v[52:55], v[32:35], v[112:115]
    v_mfma_f32_16x16x32_bf16 v[116:119], v[52:55], v[36:39], v[116:119]
    v_mfma_f32_16x16x32_bf16 v[120:123], v[52:55], v[40:43], v[120:123]
    v_mfma_f32_16x16x32_bf16 v[124:127], v[52:55], v[44:47], v[124:127]
    v_mfma_f32_16x16x32_bf16 v[128:131], v[32:35], v[56:59], v[128:131]
    v_mfma_f32_16x16x32_bf16 v[132:135], v[36:39], v[56:59], v[132:135]
    v_mfma_f32_16x16x32_bf16 v[136:139], v[40:43], v[56:59], v[136:139]
    v_mfma_f32_16x16x32_bf16 v[140:143], v[44:47], v[56:59], v[140:143]
    v_mfma_f32_16x16x32_bf16 v[144:147], v[32:35], v[60:63], v[144:147]
    v_mfma_f32_16x16x32_bf16 v[148:151], v[36:39], v[60:63], v[148:151]
    v_mfma_f32_16x16x32_bf16 v[152:155], v[40:43], v[60:63], v[152:155]
    v_mfma_f32_16x16x32_bf16 v[156:159], v[44:47], v[60:63], v[156:159]
    s_waitcnt lgkmcnt(0)
    ds_read_b128 v[32:35], v23 offset:0
    ds_read_b64_tr_b16 v[48:49], v24 offset:8192
    ds_read_b64_tr_b16 v[50:51], v24 offset:9216
    ds_read_b128 v[36:39], v23 offset:2048
    ds_read_b64_tr_b16 v[52:53], v25 offset:8192
    ds_read_b64_tr_b16 v[54:55], v25 offset:9216
    ds_read_b128 v[40:43], v23 offset:4096
    ds_read_b64_tr_b16 v[56:57], v26 offset:8192
    ds_read_b64_tr_b16 v[58:59], v26 offset:9216
    ds_read_b128 v[44:47], v23 offset:6144
    ds_read_b64_tr_b16 v[60:61], v27 offset:8192
    ds_read_b64_tr_b16 v[62:63], v27 offset:9216
    v_mfma_f32_16x16x32_bf16 v[96:99], v[80:83], v[64:67], v[96:99]
    v_mfma_f32_16x16x32_bf16 v[100:103], v[80:83], v[68:71], v[100:103]
    v_mfma_f32_16x16x32_bf16 v[104:107], v[80:83], v[72:75], v[104:107]
    v_mfma_f32_16x16x32_bf16 v[108:111], v[80:83], v[76:79], v[108:111]
    v_mfma_f32_16x16x32_bf16 v[112:115], v[84:87], v[64:67], v[112:115]
    v_mfma_f32_16x16x32_bf16 v[116:119], v[84:87], v[68:71], v[116:119]
    v_mfma_f32_16x16x32_bf16 v[120:123], v[84:87], v[72:75], v[120:123]
    v_mfma_f32_16x16x32_bf16 v[124:127], v[84:87], v[76:79], v[124:127]
    v_mfma_f32_16x16x32_bf16 v[128:131], v[64:67], v[88:91], v[128:131]
    v_mfma_f32_16x16x32_bf16 v[132:135], v[68:71], v[88:91], v[132:135]
    v_mfma_f32_16x16x32_bf16 v[136:139], v[72:75], v[88:91], v[136:139]
    v_mfma_f32_16x16x32_bf16 v[140:143], v[76:79], v[88:91], v[140:143]
    v_mfma_f32_16x16x32_bf16 v[144:147], v[64:67], v[92:95], v[144:147]
    v_mfma_f32_16x16x32_bf16 v[148:151], v[68:71], v[92:95], v[148:151]
    v_mfma_f32_16x16x32_bf16 v[152:155], v[72:75], v[92:95], v[152:155]
    v_mfma_f32_16x16x32_bf16 v[156:159], v[76:79], v[92:95], v[156:159]
    s_waitcnt lgkmcnt(0)
    s_add_u32 s38, s38, 1
    s_cmp_eq_u32 s38, 3
    s_cbranch_scc1 L_ge0
    s_barrier
    ds_read_b128 v[64:67], v16 offset:0
    ds_read_b64_tr_b16 v[80:81], v18 offset:0
    ds_read_b64_tr_b16 v[82:83], v18 offset:1024
    ds_read_b128 v[68:71], v16 offset:2048
    ds_read_b64_tr_b16 v[84:85], v19 offset:0
    ds_read_b64_tr_b16 v[86:87], v19 offset:1024
    ds_read_b128 v[72:75], v16 offset:4096
    ds_read_b64_tr_b16 v[88:89], v20 offset:0
    ds_read_b64_tr_b16 v[90:91], v20 offset:1024
    ds_read_b128 v[76:79], v16 offset:6144
    ds_read_b64_tr_b16 v[92:93], v21 offset:0
    ds_read_b64_tr_b16 v[94:95], v21 offset:1024
    v_mfma_f32_16x16x32_bf16 v[96:99], v[48:51], v[32:35], v[96:99]
    v_mfma_f32_16x16x32_bf16 v[100:103], v[48:51], v[36:39], v[100:103]
    v_mfma_f32_16x16x32_bf16 v[104:107], v[48:51], v[40:43], v[104:107]
    v_mfma_f32_16x16x32_bf16 v[108:111], v[48:51], v[44:47], v[108:111]
    v_mfma_f32_16x16x32_bf16 v[112:115], v[52:55], v[32:35], v[112:115]
    v_mfma_f32_16x16x32_bf16 v[116:119], v[52:55], v[36:39], v[116:119]
    v_mfma_f32_16x16x32_bf16 v[120:123], v[52:55], v[40:43], v[120:123]
    v_mfma_f32_16x16x32_bf16 v[124:127], v[52:55], v[44:47], v[124:127]
    v_mfma_f32_16x16x32_bf16 v[128:131], v[32:35], v[56:59], v[128:131]
    v_mfma_f32_16x16x32_bf16 v[132:135], v[36:39], v[56:59], v[132:135]
    v_mfma_f32_16x16x32_bf16 v[136:139], v[40:43], v[56:59], v[136:139]
    v_mfma_f32_16x16x32_bf16 v[140:143], v[44:47], v[56:59], v[140:143]
    v_mfma_f32_16x16x32_bf16 v[144:147], v[32:35], v[60:63], v[144:147]
    v_mfma_f32_16x16x32_bf16 v[148:151], v[36:39], v[60:63], v[148:151]
    v_mfma_f32_16x16x32_bf16 v[152:155], v[40:43], v[60:63], v[152:155]
    v_mfma_f32_16x16x32_bf16 v[156:159], v[44:47], v[60:63], v[156:159]
    s_branch L_g0
L_ge0:
    v_mfma_f32_16x16x32_bf16 v[96:99], v[48:51], v[32:35], v[96:99]
    v_mov_b32 v64, 0
    v_mov_b32 v65, 0
    v_mfma_f32_16x16x32_bf16 v[100:103], v[48:51], v[36:39], v[100:103]
    v_mov_b32 v66, 0
    v_mov_b32 v67, 0
    v_mfma_f32_16x16x32_bf16 v[104:107], v[48:51], v[40:43], v[104:107]
    v_mov_b32 v68, 0
    v_mov_b32 v69, 0
    v_mfma_f32_16x16x32_bf16 v[108:111], v[48:51], v[44:47], v[108:111]
    v_mov_b32 v70, 0
    v_mov_b32 v71, 0
    v_mfma_f32_16x16x32_bf16 v[112:115], v[52:55], v[32:35], v[112:115]
    v_mov_b32 v72, 0
    v_mov_b32 v73, 0
    v_mfma_f32_16x16x32_bf16 v[116:119], v[52:55], v[36:39], v[116:119]
    v_mov_b32 v74, 0
    v_mov_b32 v75, 0
    v_mfma_f32_16x16x32_bf16 v[120:123], v[52:55], v[40:43], v[120:123]
    v_mov_b32 v76, 0
    v_mov_b32 v77, 0
    v_mfma_f32_16x16x32_bf16 v[124:127], v[52:55], v[44:47], v[124:127]
    v_mov_b32 v78, 0
    v_mov_b32 v79, 0
    v_mfma_f32_16x16x32_bf16 v[128:131], v[32:35], v[56:59], v[128:131]
    v_mov_b32 v80, 0
    v_mov_b32 v81, 0
    v_mfma_f32_16x16x32_bf16 v[132:135], v[36:39], v[56:59], v[132:135]
    v_mov_b32 v82, 0
    v_mov_b32 v83, 0
    v_mfma_f32_16x16x32_bf16 v[136:139], v[40:43], v[56:59], v[136:139]
    v_mov_b32 v84, 0
    v_mov_b32 v85, 0
    v_mfma_f32_16x16x32_bf16 v[140:143], v[44:47], v[56:59], v[140:143]
    v_mov_b32 v86, 0
    v_mov_b32 v87, 0
    v_mfma_f32_16x16x32_bf16 v[144:147], v[32:35], v[60:63], v[144:147]
    v_mov_b32 v88, 0
    v_mov_b32 v89, 0
    v_mfma_f32_16x16x32_bf16 v[148:151], v[36:39], v[60:63], v[148:151]
    v_mov_b32 v90, 0
    v_mov_b32 v91, 0
    v_mfma_f32_16x16x32_bf16 v[152:155], v[40:43], v[60:63], v[152:155]
    v_mov_b32 v92, 0
    v_mov_b32 v93, 0
    v_mfma_f32_16x16x32_bf16 v[156:159], v[44:47], v[60:63], v[156:159]
    v_mov_b32 v94, 0
    v_mov_b32 v95, 0
    s_mov_b32 s38, 0
    s_mov_b32 s62, 0
    v_cvt_pk_bf16_f32 v96, v96, v97
    v_cvt_pk_bf16_f32 v97, v98, v99
    v_cvt_pk_bf16_f32 v98, v100, v101
    v_cvt_pk_bf16_f32 v99, v102, v103
    v_cvt_pk_bf16_f32 v104, v104, v105
    v_cvt_pk_bf16_f32 v105, v106, v107
    v_cvt_pk_bf16_f32 v106, v108, v109
    v_cvt_pk_bf16_f32 v107, v110, v111
    v_mov_b32 v41, 0x3f803f80
    v_permlane16_swap_b32 v96, v98
    v_permlane16_swap_b32 v97, v99
    ds_write_b128 v160, v[96:99] offset:0
    v_permlane16_swap_b32 v104, v106
    v_permlane16_swap_b32 v105, v107
    ds_write_b128 v160, v[104:107] offset:4608
    v_cvt_pk_bf16_f32 v128, v128, v129
    v_cvt_pk_bf16_f32 v129, v130, v131
    v_cvt_pk_bf16_f32 v130, v132, v133
    v_cvt_pk_bf16_f32 v131, v134, v135
    ds_write_b128 v162, v[128:131] offset:0
    v_cvt_pk_bf16_f32 v136, v136, v137
    v_cvt_pk_bf16_f32 v137, v138, v139
    v_cvt_pk_bf16_f32 v138, v140, v141
    v_cvt_pk_bf16_f32 v139, v142, v143
    ds_write_b128 v162, v[136:139] offset:4608
    v_cvt_pk_bf16_f32 v144, v144, v145
    v_cvt_pk_bf16_f32 v145, v146, v147
    v_cvt_pk_bf16_f32 v146, v148, v149
    v_cvt_pk_bf16_f32 v147, v150, v151
    ds_write_b128 v163, v[144:147] offset:0
    v_cvt_pk_bf16_f32 v152, v152, v153
    v_cvt_pk_bf16_f32 v153, v154, v155
    v_cvt_pk_bf16_f32 v154, v156, v157
    v_cvt_pk_bf16_f32 v155, v158, v159
    ds_write_b128 v163, v[152:155] offset:4608
    s_branch L_ep
L_g1:
    s_waitcnt lgkmcnt(0)
    ds_read_b128 v[32:35], v17 offset:0
    ds_read_b64_tr_b16 v[48:49], v18 offset:8192
    ds_read_b64_tr_b16 v[50:51], v18 offset:9216
    ds_read_b128 v[36:39], v17 offset:2048
    ds_read_b64_tr_b16 v[52:53], v19 offset:8192
    ds_read_b64_tr_b16 v[54:55], v19 offset:9216
    ds_read_b128 v[40:43], v17 offset:4096
    ds_read_b64_tr_b16 v[56:57], v20 offset:8192
    ds_read_b64_tr_b16 v[58:59], v20 offset:9216
    ds_read_b128 v[44:47], v17 offset:6144
    v_mfma_f32_16x16x32_bf16 v[96:99], v[80:83], v[64:67], v[96:99]
    v_mfma_f32_16x16x32_bf16 v[100:103], v[80:83], v[68:71], v[100:103]
    v_mfma_f32_16x16x32_bf16 v[104:107], v[80:83], v[72:75], v[104:107]
    v_mfma_f32_16x16x32_bf16 v[108:111], v[80:83], v[76:79], v[108:111]
    v_mfma_f32_16x16x32_bf16 v[112:115], v[84:87], v[64:67], v[112:115]
    v_mfma_f32_16x16x32_bf16 v[116:119], v[84:87], v[68:71], v[116:119]
    v_mfma_f32_16x16x32_bf16 v[120:123], v[84:87], v[72:75], v[120:123]
    v_mfma_f32_16x16x32_bf16 v[124:127], v[84:87], v[76:79], v[124:127]
    v_mfma_f32_16x16x32_bf16 v[128:131], v[88:91], v[64:67], v[128:131]
    v_mfma_f32_16x16x32_bf16 v[132:135], v[88:91], v[68:71], v[132:135]
    v_mfma_f32_16x16x32_bf16 v[136:139], v[88:91], v[72:75], v[136:139]
    v_mfma_f32_16x16x32_bf16 v[140:143], v[88:91], v[76:79], v[140:143]
    s_waitcnt lgkmcnt(0)
    s_barrier
    ds_read_b128 v[64:67], v16 offset:49152
    ds_read_b64_tr_b16 v[80:81], v18 offset:49152
    ds_read_b64_tr_b16 v[82:83], v18 offset:50176
    ds_read_b128 v[68:71], v16 offset:51200
    ds_read_b64_tr_b16 v[84:85], v19 offset:49152
    ds_read_b64_tr_b16 v[86:87], v19 offset:50176
    ds_read_b128 v[72:75], v16 offset:53248
    ds_read_b64_tr_b16 v[88:89], v20 offset:49152
    ds_read_b64_tr_b16 v[90:91], v20 offset:50176
    ds_read_b128 v[76:79], v16 offset:55296
    v_mfma_f32_16x16x32_bf16 v[96:99], v[48:51], v[32:35], v[96:99]
    v_mfma_f32_16x16x32_bf16 v[100:103], v[48:51], v[36:39], v[100:103]
    v_mfma_f32_16x16x32_bf16 v[104:107], v[48:51], v[40:43], v[104:107]
    v_mfma_f32_16x16x32_bf16 v[108:111], v[48:51], v[44:47], v[108:111]
    v_mfma_f32_16x16x32_bf16 v[112:115], v[52:55], v[32:35], v[112:115]
    v_mfma_f32_16x16x32_bf16 v[116:119], v[52:55], v[36:39], v[116:119]
    v_mfma_f32_16x16x32_bf16 v[120:123], v[52:55], v[40:43], v[120:123]
    v_mfma_f32_16x16x32_bf16 v[124:127], v[52:55], v[44:47], v[124:127]
    v_mfma_f32_16x16x32_bf16 v[128:131], v[56:59], v[32:35], v[128:131]
    v_mfma_f32_16x16x32_bf16 v[132:135], v[56:59], v[36:39], v[132:135]
    v_mfma_f32_16x16x32_bf16 v[136:139], v[56:59], v[40:43], v[136:139]
    v_mfma_f32_16x16x32_bf16 v[140:143], v[56:59], v[44:47], v[140:143]
    s_waitcnt lgkmcnt(0)
    ds_read_b128 v[32:35], v17 offset:49152
    ds_read_b64_tr_b16 v[48:49], v18 offset:57344
    ds_read_b64_tr_b16 v[50:51], v18 offset:58368
    ds_read_b128 v[36:39], v17 offset:51200
    ds_read_b64_tr_b16 v[52:53], v19 offset:57344
    ds_read_b64_tr_b16 v[54:55], v19 offset:58368
    ds_read_b128 v[40:43], v17 offset:53248
    ds_read_b64_tr_b16 v[56:57], v20 offset:57344
    ds_read_b64_tr_b16 v[58:59], v20 offset:58368
    ds_read_b128 v[44:47], v17 offset:55296
    v_mfma_f32_16x16x32_bf16 v[96:99], v[80:83], v[64:67], v[96:99]
    v_mfma_f32_16x16x32_bf16 v[100:103], v[80:83], v[68:71], v[100:103]
    v_mfma_f32_16x16x32_bf16 v[104:107], v[80:83], v[72:75], v[104:107]
    v_mfma_f32_16x16x32_bf16 v[108:111], v[80:83], v[76:79], v[108:111]
    v_mfma_f32_16x16x32_bf16 v[112:115], v[84:87], v[64:67], v[112:115]
    v_mfma_f32_16x16x32_bf16 v[116:119], v[84:87], v[68:71], v[116:119]
    v_mfma_f32_16x16x32_bf16 v[120:123], v[84:87], v[72:75], v[120:123]
    v_mfma_f32_16x16x32_bf16 v[124:127], v[84:87], v[76:79], v[124:127]
    v_mfma_f32_16x16x32_bf16 v[128:131], v[88:91], v[64:67], v[128:131]
    v_mfma_f32_16x16x32_bf16 v[132:135], v[88:91], v[68:71], v[132:135]
    v_mfma_f32_16x16x32_bf16 v[136:139], v[88:91], v[72:75], v[136:139]
    v_mfma_f32_16x16x32_bf16 v[140:143], v[88:91], v[76:79], v[140:143]
    s_waitcnt lgkmcnt(0)
    s_barrier
    ds_read_b128 v[64:67], v22 offset:0
    ds_read_b64_tr_b16 v[80:81], v24 offset:0
    ds_read_b64_tr_b16 v[82:83], v24 offset:1024
    ds_read_b128 v[68:71], v22 offset:2048
    ds_read_b64_tr_b16 v[84:85], v25 offset:0
    ds_read_b64_tr_b16 v[86:87], v25 offset:1024
    ds_read_b128 v[72:75], v22 offset:4096
    ds_read_b64_tr_b16 v[88:89], v26 offset:0
    ds_read_b64_tr_b16 v[90:91], v26 offset:1024
    ds_read_b128 v[76:79], v22 offset:6144
    v_mfma_f32_16x16x32_bf16 v[96:99], v[48:51], v[32:35], v[96:99]
    v_mfma_f32_16x16x32_bf16 v[100:103], v[48:51], v[36:39], v[100:103]
    v_mfma_f32_16x16x32_bf16 v[104:107], v[48:51], v[40:43], v[104:107]
    v_mfma_f32_16x16x32_bf16 v[108:111], v[48:51], v[44:47], v[108:111]
    v_mfma_f32_16x16x32_bf16 v[112:115], v[52:55], v[32:35], v[112:115]
    v_mfma_f32_16x16x32_bf16 v[116:119], v[52:55], v[36:39], v[116:119]
    v_mfma_f32_16x16x32_bf16 v[120:123], v[52:55], v[40:43], v[120:123]
    v_mfma_f32_16x16x32_bf16 v[124:127], v[52:55], v[44:47], v[124:127]
    v_mfma_f32_16x16x32_bf16 v[128:131], v[56:59], v[32:35], v[128:131]
    v_mfma_f32_16x16x32_bf16 v[132:135], v[56:59], v[36:39], v[132:135]
    v_mfma_f32_16x16x32_bf16 v[136:139], v[56:59], v[40:43], v[136:139]
    v_mfma_f32_16x16x32_bf16 v[140:143], v[56:59], v[44:47], v[140:143]
    s_waitcnt lgkmcnt(0)
    ds_read_b128 v[32:35], v23 offset:0
    ds_read_b64_tr_b16 v[48:49], v24 offset:8192
    ds_read_b64_tr_b16 v[50:51], v24 offset:9216
    ds_read_b128 v[36:39], v23 offset:2048
    ds_read_b64_tr_b16 v[52:53], v25 offset:8192
    ds_read_b64_tr_b16 v[54:55], v25 offset:9216
    ds_read_b128 v[40:43], v23 offset:4096
    ds_read_b64_tr_b16 v[56:57], v26 offset:8192
    ds_read_b64_tr_b16 v[58:59], v26 offset:9216
    ds_read_b128 v[44:47], v23 offset:6144
    v_mfma_f32_16x16x32_bf16 v[96:99], v[80:83], v[64:67], v[96:99]
    v_mfma_f32_16x16x32_bf16 v[100:103], v[80:83], v[68:71], v[100:103]
    v_mfma_f32_16x16x32_bf16 v[104:107], v[80:83], v[72:75], v[104:107]
    v_mfma_f32_16x16x32_bf16 v[108:111], v[80:83], v[76:79], v[108:111]
    v_mfma_f32_16x16x32_bf16 v[112:115], v[84:87], v[64:67], v[112:115]
    v_mfma_f32_16x16x32_bf16 v[116:119], v[84:87], v[68:71], v[116:119]
    v_mfma_f32_16x16x32_bf16 v[120:123], v[84:87], v[72:75], v[120:123]
    v_mfma_f32_16x16x32_bf16 v[124:127], v[84:87], v[76:79], v[124:127]
    v_mfma_f32_16x16x32_bf16 v[128:131], v[88:91], v[64:67], v[128:131]
    v_mfma_f32_16x16x32_bf16 v[132:135], v[88:91], v[68:71], v[132:135]
    v_mfma_f32_16x16x32_bf16 v[136:139], v[88:91], v[72:75], v[136:139]
    v_mfma_f32_16x16x32_bf16 v[140:143], v[88:91], v[76:79], v[140:143]
    s_waitcnt lgkmcnt(0)
    s_add_u32 s38, s38, 1
    s_cmp_eq_u32 s38, 3
    s_cbranch_scc1 L_ge1
    s_barrier
    ds_read_b128 v[64:67], v16 offset:0
    ds_read_b64_tr_b16 v[80:81], v18 offset:0
    ds_read_b64_tr_b16 v[82:83], v18 offset:1024
    ds_read_b128 v[68:71], v16 offset:2048
    ds_read_b64_tr_b16 v[84:85], v19 offset:0
    ds_read_b64_tr_b16 v[86:87], v19 offset:1024
    ds_read_b128 v[72:75], v16 offset:4096
    ds_read_b64_tr_b16 v[88:89], v20 offset:0
    ds_read_b64_tr_b16 v[90:91], v20 offset:1024
    ds_read_b128 v[76:79], v16 offset:6144
    v_mfma_f32_16x16x32_bf16 v[96:99], v[48:51], v[32:35], v[96:99]
    v_mfma_f32_16x16x32_bf16 v[100:103], v[48:51], v[36:39], v[100:103]
    v_mfma_f32_16x16x32_bf16 v[104:107], v[48:51], v[40:43], v[104:107]
    v_mfma_f32_16x16x32_bf16 v[108:111], v[48:51], v[44:47], v[108:111]
    v_mfma_f32_16x16x32_bf16 v[112:115], v[52:55], v[32:35], v[112:115]
    v_mfma_f32_16x16x32_bf16 v[116:119], v[52:55], v[36:39], v[116:119]
    v_mfma_f32_16x16x32_bf16 v[120:123], v[52:55], v[40:43], v[120:123]
    v_mfma_f32_16x16x32_bf16 v[124:127], v[52:55], v[44:47], v[124:127]
    v_mfma_f32_16x16x32_bf16 v[128:131], v[56:59], v[32:35], v[128:131]
    v_mfma_f32_16x16x32_bf16 v[132:135], v[56:59], v[36:39], v[132:135]
    v_mfma_f32_16x16x32_bf16 v[136:139], v[56:59], v[40:43], v[136:139]
    v_mfma_f32_16x16x32_bf16 v[140:143], v[56:59], v[44:47], v[140:143]
    s_branch L_g1
L_ge1:
    v_mfma_f32_16x16x32_bf16 v[96:99], v[48:51], v[32:35], v[96:99]
    v_mov_b32 v64, 0
    v_mov_b32 v65, 0
    v_mov_b32 v66, 0
    v_mfma_f32_16x16x32_bf16 v[100:103], v[48:51], v[36:39], v[100:103]
    v_mov_b32 v67, 0
    v_mov_b32 v68, 0
    v_mov_b32 v69, 0
    v_mfma_f32_16x16x32_bf16 v[104:107], v[48:51], v[40:43], v[104:107]
    v_mov_b32 v70, 0
    v_mov_b32 v71, 0
    v_mov_b32 v72, 0
    v_mfma_f32_16x16x32_bf16 v[108:111], v[48:51], v[44:47], v[108:111]
    v_mov_b32 v73, 0
    v_mov_b32 v74, 0
    v_mov_b32 v75, 0
    v_mfma_f32_16x16x32_bf16 v[112:115], v[52:55], v[32:35], v[112:115]
    v_mov_b32 v76, 0
    v_mov_b32 v77, 0
    v_mov_b32 v78, 0
    v_mfma_f32_16x16x32_bf16 v[116:119], v[52:55], v[36:39], v[116:119]
    v_mov_b32 v79, 0
    v_mov_b32 v80, 0
    v_mov_b32 v81, 0
    v_mfma_f32_16x16x32_bf16 v[120:123], v[52:55], v[40:43], v[120:123]
    v_mov_b32 v82, 0
    v_mov_b32 v83, 0
    v_mov_b32 v84, 0
    v_mfma_f32_16x16x32_bf16 v[124:127], v[52:55], v[44:47], v[124:127]
    v_mov_b32 v85, 0
    v_mov_b32 v86, 0
    v_mov_b32 v87, 0
    v_mfma_f32_16x16x32_bf16 v[128:131], v[56:59], v[32:35], v[128:131]
    v_mov_b32 v88, 0
    v_mov_b32 v89, 0
    v_mfma_f32_16x16x32_bf16 v[132:135], v[56:59], v[36:39], v[132:135]
    v_mov_b32 v90, 0
    v_mov_b32 v91, 0
    v_mfma_f32_16x16x32_bf16 v[136:139], v[56:59], v[40:43], v[136:139]
    v_mov_b32 v92, 0
    v_mov_b32 v93, 0
    v_mfma_f32_16x16x32_bf16 v[140:143], v[56:59], v[44:47], v[140:143]
    v_mov_b32 v94, 0
    v_mov_b32 v95, 0
    s_mov_b32 s38, 0
    s_mov_b32 s62, 0
    v_cvt_pk_bf16_f32 v96, v96, v97
    v_cvt_pk_bf16_f32 v97, v98, v99
    v_cvt_pk_bf16_f32 v98, v100, v101
    v_cvt_pk_bf16_f32 v99, v102, v103
    v_cvt_pk_bf16_f32 v104, v104, v105
    v_cvt_pk_bf16_f32 v105, v106, v107
    v_cvt_pk_bf16_f32 v106, v108, v109
    v_cvt_pk_bf16_f32 v107, v110, v111
    v_mov_b32 v41, 0x3f803f80
    v_permlane16_swap_b32 v96, v98
    v_permlane16_swap_b32 v97, v99
    ds_write_b128 v160, v[96:99] offset:0
    v_permlane16_swap_b32 v104, v106
    v_permlane16_swap_b32 v105, v107
    ds_write_b128 v160, v[104:107] offset:4608
    v_permlane16_swap_b32 v128, v132
    v_permlane16_swap_b32 v129, v133
    v_permlane16_swap_b32 v130, v134
    v_permlane16_swap_b32 v131, v135
    v_permlane16_swap_b32 v136, v140
    v_permlane16_swap_b32 v137, v141
    v_permlane16_swap_b32 v138, v142
    v_permlane16_swap_b32 v139, v143
    s_mov_b32 exec_lo, 0
    ds_write_b32 v161, v132 offset:2048
    ds_write_b32 v161, v140 offset:2176
    s_mov_b32 exec_lo, -1
    v_mul_f32 v128, v164, v128
    v_mul_f32 v129, v164, v129
    v_mul_f32 v130, v164, v130
    v_mul_f32 v131, v164, v131
    v_cvt_pk_bf16_f32 v144, v128, v129
    v_cvt_pk_bf16_f32 v145, v130, v131
    v_cvt_pk_bf16_f32 v146, v132, v133
    v_cvt_pk_bf16_f32 v147, v134, v135
    ds_write_b32 v162, v144 offset:0
    ds_write_b32 v163, v145 offset:0
    v_mul_f32 v136, v164, v136
    v_mul_f32 v137, v164, v137
    v_mul_f32 v138, v164, v138
    v_mul_f32 v139, v164, v139
    v_cvt_pk_bf16_f32 v152, v136, v137
    v_cvt_pk_bf16_f32 v153, v138, v139
    v_cvt_pk_bf16_f32 v154, v140, v141
    v_cvt_pk_bf16_f32 v155, v142, v143
    ds_write_b32 v162, v152 offset:128
    ds_write_b32 v163, v153 offset:128
    s_mov_b32 exec_hi, 0
    ds_write_b16 v165, v146 offset:224
    ds_write_b16_d16_hi v165, v146 offset:240
    ds_write_b16 v165, v147 offset:256
    ds_write_b16_d16_hi v165, v147 offset:272
    ds_write_b16 v165, v154 offset:4832
    ds_write_b16_d16_hi v165, v154 offset:4848
    ds_write_b16 v165, v155 offset:4864
    ds_write_b16_d16_hi v165, v155 offset:4880
    s_mov_b32 exec_hi, -1
    s_waitcnt vmcnt(0) lgkmcnt(0)
    s_barrier
    v_pk_mul_f32 v[112:113], v[112:113], s[70:71]
    v_pk_mul_f32 v[114:115], v[114:115], s[70:71]
    v_pk_mul_f32 v[116:117], v[116:117], s[70:71]
    v_pk_mul_f32 v[118:119], v[118:119], s[70:71]
    v_cvt_pk_bf16_f32 v16, v112, v113
    v_cvt_pk_bf16_f32 v17, v114, v115
    v_cvt_pk_bf16_f32 v18, v116, v117
    v_cvt_pk_bf16_f32 v19, v118, v119
    v_pk_mul_f32 v[120:121], v[120:121], s[70:71]
    v_pk_mul_f32 v[122:123], v[122:123], s[70:71]
    v_pk_mul_f32 v[124:125], v[124:125], s[70:71]
    v_pk_mul_f32 v[126:127], v[126:127], s[70:71]
    v_cvt_pk_bf16_f32 v20, v120, v121
    v_cvt_pk_bf16_f32 v21, v122, v123
    v_cvt_pk_bf16_f32 v22, v124, v125
    v_cvt_pk_bf16_f32 v23, v126, v127
    v_mov_b32 v43, 0x3f803f80
    v_permlane16_swap_b32 v16, v18
    v_permlane16_swap_b32 v17, v19
    v_permlane16_swap_b32 v20, v22
    v_permlane16_swap_b32 v21, v23
    v_cmp_gt_u32 vcc, 32, v1
    v_mov_b32 v44, 0
    v_mov_b32 v45, 0
    v_mov_b32 v46, 0
    v_mov_b32 v47, 0
    v_mov_b32 v48, 0
    v_mov_b32 v49, 0
    v_mov_b32 v50, 0
    v_mov_b32 v51, 0
    v_mov_b32 v52, 0
    v_mov_b32 v53, 0
    v_mov_b32 v54, 0
    v_mov_b32 v55, 0
    v_mov_b32 v56, 0
    v_mov_b32 v57, 0
    v_mov_b32 v58, 0
    v_mov_b32 v59, 0
    v_mfma_f32_32x32x16_bf16 v[128:143], v[96:99], v[16:19], 0
    v_mfma_f32_32x32x16_bf16 v[144:159], v[96:99], v[20:23], 0
    s_branch L_ep2
L_ep:
    v_pk_mul_f32 v[112:113], v[112:113], s[70:71]
    v_pk_mul_f32 v[114:115], v[114:115], s[70:71]
    v_pk_mul_f32 v[116:117], v[116:117], s[70:71]
    v_pk_mul_f32 v[118:119], v[118:119], s[70:71]
    v_cvt_pk_bf16_f32 v16, v112, v113
    v_cvt_pk_bf16_f32 v17, v114, v115
    v_cvt_pk_bf16_f32 v18, v116, v117
    v_cvt_pk_bf16_f32 v19, v118, v119
    v_pk_mul_f32 v[120:121], v[120:121], s[70:71]
    v_pk_mul_f32 v[122:123], v[122:123], s[70:71]
    v_pk_mul_f32 v[124:125], v[124:125], s[70:71]
    v_pk_mul_f32 v[126:127], v[126:127], s[70:71]
    v_cvt_pk_bf16_f32 v20, v120, v121
    v_cvt_pk_bf16_f32 v21, v122, v123
    v_cvt_pk_bf16_f32 v22, v124, v125
    v_cvt_pk_bf16_f32 v23, v126, v127
    v_mov_b32 v43, 0x3f803f80
    v_permlane16_swap_b32 v16, v18
    v_permlane16_swap_b32 v17, v19
    v_permlane16_swap_b32 v20, v22
    v_permlane16_swap_b32 v21, v23
    v_cmp_gt_u32 vcc, 32, v1
    v_mov_b32 v44, 0
    v_mov_b32 v45, 0
    v_mov_b32 v46, 0
    v_mov_b32 v47, 0
    v_mov_b32 v48, 0
    v_mov_b32 v49, 0
    v_mov_b32 v50, 0
    v_mov_b32 v51, 0
    v_mov_b32 v52, 0
    v_mov_b32 v53, 0
    v_mov_b32 v54, 0
    v_mov_b32 v55, 0
    v_mov_b32 v56, 0
    v_mov_b32 v57, 0
    v_mov_b32 v58, 0
    v_mov_b32 v59, 0
    s_waitcnt vmcnt(0) lgkmcnt(0)
    v_mfma_f32_32x32x16_bf16 v[128:143], v[96:99], v[16:19], 0
    v_mfma_f32_32x32x16_bf16 v[144:159], v[96:99], v[20:23], 0
    s_barrier
L_ep2:
    ds_read_b32 v8, v161 offset:2048
    ds_read_b32 v9, v161 offset:2176
    ds_read_b32 v40, v4
    ds_read_b32 v24, v166
    ds_read_b128 v[32:35], v3
    s_mov_b64 exec, s[34:35]
    ds_read_b128 v[44:47], v5 offset:0
    ds_read_b128 v[52:55], v5 offset:640
    s_mov_b64 exec, -1
    s_mov_b32 s32, 0xbfb8aa3b
    s_cmp_ge_u32 s21, 16
    s_cselect_b32 s32, 0x3fb8aa3b, s32
    s_nop 0
    v_max3_f32 v10, v128, v129, v130
    v_max3_f32 v10, v10, v131, v132
    v_max3_f32 v10, v10, v133, v134
    v_max3_f32 v10, v10, v135, v136
    v_max3_f32 v11, v144, v145, v146
    v_max3_f32 v11, v11, v147, v148
    v_max3_f32 v11, v11, v149, v150
    v_max3_f32 v11, v11, v151, v152
    v_cndmask_b32 v10, v11, v10, vcc
    v_lshrrev_b32 v10, 16, v10
    v_xor_b32 v25, 0xc2288000, v10
    s_waitcnt lgkmcnt(3)
    v_mul_f32 v8, s32, v8
    v_mfma_f32_32x32x4_2b_bf16 v[96:127], v[40:41], v[24:25], 0 cbsz:1 abid:0
    v_mul_f32 v9, s32, v9
    v_exp_f32 v8, v8
    v_exp_f32 v9, v9
    v_mov_b32 v152, 0
    v_mov_b32 v153, 0
    v_mov_b32 v154, 0
    v_mov_b32 v155, 0
    v_mov_b32 v156, 0
    v_mov_b32 v157, 0
    v_mov_b32 v158, 0
    v_mov_b32 v159, 0
    v_add_f32 v8, 1.0, v8
    v_add_f32 v9, 1.0, v9
    v_rcp_f32 v8, v8
    v_rcp_f32 v9, v9
    s_waitcnt lgkmcnt(0)
    s_nop 1
    v_mfma_f32_32x32x16_bf16 v[96:111], v[32:35], v[16:19], v[96:111]
    v_mfma_f32_32x32x16_bf16 v[112:127], v[32:35], v[20:23], v[112:127]
    v_lshrrev_b32 v165, 5, v1
    v_mul_u32_u24 v165, 73600, v165
    v_lshl_add_u32 v165, v1, 2, v165
    s_setprio 1
    s_nop 6
.p2align 6
L_loop:
    v_exp_f32 v96, v96
    v_exp_f32 v97, v97
    v_smfmac_f32_32x32x32_bf16 v[80:95], v[56:59], v[152:159], v6
    ds_read_b128 v[32:35], v3 offset:4608
    ds_read_b32 v42, v4 offset:9728
    v_exp_f32 v98, v98
    v_exp_f32 v99, v99
    v_exp_f32 v100, v100
    v_exp_f32 v101, v101
    v_mfma_f32_32x32x4_2b_bf16 v[128:159], v[40:41], v[24:25], 0 cbsz:1 abid:1
    v_exp_f32 v102, v102
    v_exp_f32 v103, v103
    v_exp_f32 v104, v104
    v_exp_f32 v105, v105
    v_exp_f32 v106, v106
    v_exp_f32 v107, v107
    v_exp_f32 v108, v108
    v_exp_f32 v109, v109
    v_smfmac_f32_32x32x32_bf16 v[64:79], v[44:47], v[96:103], v6
    s_waitcnt lgkmcnt(0)
    s_mov_b64 exec, s[34:35]
    ds_read_b128 v[48:51], v5 offset:4608
    ds_read_b128 v[56:59], v5 offset:5248
    s_mov_b64 exec, -1
    v_exp_f32 v110, v110
    v_exp_f32 v111, v111
    v_exp_f32 v112, v112
    v_exp_f32_e64 v113, v113
    v_smfmac_f32_32x32x32_bf16 v[64:79], v[52:55], v[104:111], v6
    v_exp_f32 v114, v114
    v_exp_f32 v115, v115
    v_exp_f32 v116, v116
    v_exp_f32 v117, v117
    v_mfma_f32_32x32x16_bf16 v[128:143], v[32:35], v[16:19], v[128:143]
    v_exp_f32 v118, v118
    v_exp_f32 v119, v119
    v_exp_f32 v120, v120
    v_exp_f32 v121, v121
    v_smfmac_f32_32x32x32_bf16 v[80:95], v[44:47], v[112:119], v6
    s_waitcnt lgkmcnt(0)
    v_exp_f32 v122, v122
    v_exp_f32 v123, v123
    v_exp_f32 v124, v124
    v_mfma_f32_32x32x16_bf16 v[144:159], v[32:35], v[20:23], v[144:159]
    v_exp_f32 v125, v125
    v_exp_f32 v126, v126
    v_exp_f32 v127, v127
    v_exp_f32 v128, v128
    v_exp_f32_e64 v129, v129
    v_smfmac_f32_32x32x32_bf16 v[80:95], v[52:55], v[120:127], v6
    ds_read_b128 v[32:35], v3 offset:9728
    v_exp_f32 v130, v130
    v_exp_f32 v131, v131
    v_exp_f32 v132, v132
    v_exp_f32 v133, v133
    v_mfma_f32_32x32x4_2b_bf16 v[96:127], v[42:43], v[24:25], 0 cbsz:1 abid:0
    v_exp_f32 v134, v134
    v_exp_f32 v135, v135
    v_exp_f32 v136, v136
    v_exp_f32 v137, v137
    v_exp_f32 v138, v138
    v_exp_f32 v139, v139
    v_exp_f32 v140, v140
    v_exp_f32 v141, v141
    v_smfmac_f32_32x32x32_bf16 v[64:79], v[48:51], v[128:135], v6
    s_waitcnt lgkmcnt(0)
    s_mov_b64 exec, s[34:35]
    ds_read_b128 v[44:47], v5 offset:9728
    ds_read_b128 v[52:55], v5 offset:10368
    s_mov_b64 exec, -1
    v_exp_f32 v142, v142
    v_exp_f32 v143, v143
    v_exp_f32 v144, v144
    v_exp_f32_e64 v145, v145
    v_smfmac_f32_32x32x32_bf16 v[64:79], v[56:59], v[136:143], v6
    s_mov_b32 s56, s48
    v_exp_f32 v146, v146
    v_exp_f32 v147, v147
    v_exp_f32 v148, v148
    v_exp_f32_e64 v149, v149
    v_mfma_f32_32x32x16_bf16 v[96:111], v[32:35], v[16:19], v[96:111]
    s_mov_b32 s48, s49
    v_exp_f32 v150, v150
    v_exp_f32 v151, v151
    v_exp_f32 v152, v152
    v_exp_f32_e64 v153, v153
    v_smfmac_f32_32x32x32_bf16 v[80:95], v[48:51], v[144:151], v6
    s_waitcnt lgkmcnt(0)
    v_exp_f32 v154, v154
    v_exp_f32 v155, v155
    v_exp_f32 v156, v156
    v_mfma_f32_32x32x16_bf16 v[112:127], v[32:35], v[20:23], v[112:127]
    v_exp_f32 v157, v157
    v_exp_f32 v158, v158
    v_exp_f32 v159, v159
    v_exp_f32 v96, v96
    v_exp_f32_e64 v97, v97
    v_smfmac_f32_32x32x32_bf16 v[80:95], v[56:59], v[152:159], v6
    ds_read_b128 v[32:35], v3 offset:14336
    ds_read_b32 v40, v4 offset:19456
    v_exp_f32 v98, v98
    v_exp_f32 v99, v99
    v_exp_f32 v100, v100
    v_exp_f32 v101, v101
    v_mfma_f32_32x32x4_2b_bf16 v[128:159], v[42:43], v[24:25], 0 cbsz:1 abid:1
    v_exp_f32 v102, v102
    v_exp_f32 v103, v103
    v_exp_f32 v104, v104
    v_exp_f32 v105, v105
    v_exp_f32 v106, v106
    v_exp_f32 v107, v107
    v_exp_f32 v108, v108
    v_exp_f32 v109, v109
    v_smfmac_f32_32x32x32_bf16 v[64:79], v[44:47], v[96:103], v6
    s_waitcnt lgkmcnt(0)
    s_mov_b64 exec, s[34:35]
    ds_read_b128 v[48:51], v5 offset:14336
    ds_read_b128 v[56:59], v5 offset:14976
    s_mov_b64 exec, -1
    v_exp_f32 v110, v110
    v_exp_f32 v111, v111
    v_exp_f32 v112, v112
    v_exp_f32_e64 v113, v113
    v_smfmac_f32_32x32x32_bf16 v[64:79], v[52:55], v[104:111], v6
    v_exp_f32 v114, v114
    v_exp_f32 v115, v115
    v_exp_f32 v116, v116
    v_exp_f32 v117, v117
    v_mfma_f32_32x32x16_bf16 v[128:143], v[32:35], v[16:19], v[128:143]
    v_mov_b32 v7, s38
    v_exp_f32 v118, v118
    v_exp_f32 v119, v119
    v_exp_f32 v120, v120
    v_exp_f32_e64 v121, v121
    v_smfmac_f32_32x32x32_bf16 v[80:95], v[44:47], v[112:119], v6
    s_waitcnt lgkmcnt(0)
    v_exp_f32 v122, v122
    v_exp_f32 v123, v123
    v_exp_f32 v124, v124
    v_mfma_f32_32x32x16_bf16 v[144:159], v[32:35], v[20:23], v[144:159]
    v_exp_f32 v125, v125
    v_exp_f32 v126, v126
    v_exp_f32 v127, v127
    v_exp_f32 v128, v128
    v_exp_f32_e64 v129, v129
    v_smfmac_f32_32x32x32_bf16 v[80:95], v[52:55], v[120:127], v6
    ds_read_b128 v[32:35], v3 offset:19456
    v_exp_f32 v130, v130
    v_exp_f32 v131, v131
    v_exp_f32 v132, v132
    v_exp_f32 v133, v133
    v_mfma_f32_32x32x4_2b_bf16 v[96:127], v[40:41], v[24:25], 0 cbsz:1 abid:0
    v_exp_f32 v134, v134
    v_exp_f32 v135, v135
    v_exp_f32 v136, v136
    v_exp_f32 v137, v137
    v_exp_f32 v138, v138
    v_exp_f32 v139, v139
    v_exp_f32 v140, v140
    v_exp_f32 v141, v141
    v_smfmac_f32_32x32x32_bf16 v[64:79], v[48:51], v[128:135], v6
    s_waitcnt lgkmcnt(0)
    s_mov_b64 exec, s[34:35]
    ds_read_b128 v[44:47], v5 offset:19456
    ds_read_b128 v[52:55], v5 offset:20096
    s_mov_b64 exec, -1
    v_exp_f32 v142, v142
    v_exp_f32 v143, v143
    v_exp_f32 v144, v144
    v_exp_f32_e64 v145, v145
    v_smfmac_f32_32x32x32_bf16 v[64:79], v[56:59], v[136:143], v6
    s_mov_b32 s49, s50
    v_exp_f32 v146, v146
    v_exp_f32 v147, v147
    v_exp_f32 v148, v148
    v_exp_f32_e64 v149, v149
    v_mfma_f32_32x32x16_bf16 v[96:111], v[32:35], v[16:19], v[96:111]
    v_exp_f32 v150, v150
    v_exp_f32 v151, v151
    v_exp_f32 v152, v152
    v_exp_f32 v153, v153
    v_smfmac_f32_32x32x32_bf16 v[80:95], v[48:51], v[144:151], v6
    s_waitcnt lgkmcnt(0)
    v_exp_f32 v154, v154
    v_exp_f32 v155, v155
    v_exp_f32 v156, v156
    v_mfma_f32_32x32x16_bf16 v[112:127], v[32:35], v[20:23], v[112:127]
    ds_write_b32 v167, v7
    v_exp_f32 v157, v157
    v_exp_f32 v158, v158
    v_exp_f32 v159, v159
    v_exp_f32 v96, v96
    v_exp_f32_e64 v97, v97
    v_smfmac_f32_32x32x32_bf16 v[80:95], v[56:59], v[152:159], v6
    ds_read_b128 v[32:35], v3 offset:24064
    ds_read_b32 v42, v4 offset:29184
    v_exp_f32 v98, v98
    v_exp_f32 v99, v99
    v_exp_f32 v100, v100
    v_exp_f32 v101, v101
    v_mfma_f32_32x32x4_2b_bf16 v[128:159], v[40:41], v[24:25], 0 cbsz:1 abid:1
    v_exp_f32 v102, v102
    v_exp_f32 v103, v103
    v_exp_f32 v104, v104
    v_exp_f32 v105, v105
    v_exp_f32 v106, v106
    v_exp_f32 v107, v107
    v_exp_f32 v108, v108
    v_exp_f32 v109, v109
    v_smfmac_f32_32x32x32_bf16 v[64:79], v[44:47], v[96:103], v6
    s_waitcnt lgkmcnt(0)
    s_mov_b64 exec, s[34:35]
    ds_read_b128 v[48:51], v5 offset:24064
    ds_read_b128 v[56:59], v5 offset:24704
    s_mov_b64 exec, -1
    v_exp_f32 v110, v110
    v_exp_f32 v111, v111
    v_exp_f32 v112, v112
    v_exp_f32_e64 v113, v113
    v_smfmac_f32_32x32x32_bf16 v[64:79], v[52:55], v[104:111], v6
    v_exp_f32 v114, v114
    v_exp_f32 v115, v115
    v_exp_f32 v116, v116
    v_exp_f32 v117, v117
    v_mfma_f32_32x32x16_bf16 v[128:143], v[32:35], v[16:19], v[128:143]
    v_exp_f32 v118, v118
    v_exp_f32 v119, v119
    v_exp_f32 v120, v120
    v_exp_f32 v121, v121
    v_smfmac_f32_32x32x32_bf16 v[80:95], v[44:47], v[112:119], v6
    s_waitcnt lgkmcnt(0)
    v_exp_f32 v122, v122
    v_exp_f32 v123, v123
    v_exp_f32 v124, v124
    v_mfma_f32_32x32x16_bf16 v[144:159], v[32:35], v[20:23], v[144:159]
    v_exp_f32 v125, v125
    v_exp_f32 v126, v126
    v_exp_f32 v127, v127
    v_exp_f32 v128, v128
    v_exp_f32_e64 v129, v129
    v_smfmac_f32_32x32x32_bf16 v[80:95], v[52:55], v[120:127], v6
    ds_read_b128 v[32:35], v3 offset:29184
    v_exp_f32 v130, v130
    v_exp_f32 v131, v131
    v_exp_f32 v132, v132
    v_exp_f32 v133, v133
    v_mfma_f32_32x32x4_2b_bf16 v[96:127], v[42:43], v[24:25], 0 cbsz:1 abid:0
    v_exp_f32 v134, v134
    v_exp_f32 v135, v135
    v_exp_f32 v136, v136
    v_exp_f32 v137, v137
    v_exp_f32 v138, v138
    v_exp_f32 v139, v139
    v_exp_f32 v140, v140
    v_exp_f32 v141, v141
    v_smfmac_f32_32x32x32_bf16 v[64:79], v[48:51], v[128:135], v6
    s_waitcnt lgkmcnt(0)
    s_mov_b64 exec, s[34:35]
    ds_read_b128 v[44:47], v5 offset:29184
    ds_read_b128 v[52:55], v5 offset:29824
    s_mov_b64 exec, -1
    v_exp_f32 v142, v142
    v_exp_f32 v143, v143
    v_exp_f32 v144, v144
    v_exp_f32_e64 v145, v145
    v_smfmac_f32_32x32x32_bf16 v[64:79], v[56:59], v[136:143], v6
    v_exp_f32 v146, v146
    v_exp_f32 v147, v147
    v_exp_f32 v148, v148
    v_exp_f32 v149, v149
    v_mfma_f32_32x32x16_bf16 v[96:111], v[32:35], v[16:19], v[96:111]
    s_mov_b32 s50, s56
    v_exp_f32 v150, v150
    v_exp_f32 v151, v151
    v_exp_f32 v152, v152
    v_exp_f32_e64 v153, v153
    v_smfmac_f32_32x32x32_bf16 v[80:95], v[48:51], v[144:151], v6
    s_waitcnt lgkmcnt(0)
    v_exp_f32 v154, v154
    v_exp_f32 v155, v155
    v_exp_f32 v156, v156
    v_mfma_f32_32x32x16_bf16 v[112:127], v[32:35], v[20:23], v[112:127]
    v_exp_f32 v157, v157
    v_exp_f32 v158, v158
    v_exp_f32 v159, v159
    v_exp_f32 v96, v96
    v_exp_f32_e64 v97, v97
    v_smfmac_f32_32x32x32_bf16 v[80:95], v[56:59], v[152:159], v6
    s_setprio 0
    ds_read_b128 v[32:35], v3 offset:33792
    v_exp_f32 v98, v98
    v_exp_f32 v99, v99
    v_exp_f32 v100, v100
    v_exp_f32_e64 v101, v101
    v_mfma_f32_32x32x4_2b_bf16 v[128:159], v[42:43], v[24:25], 0 cbsz:1 abid:1
    v_exp_f32 v102, v102
    v_exp_f32 v103, v103
    v_exp_f32 v104, v104
    v_exp_f32 v105, v105
    v_exp_f32 v106, v106
    v_exp_f32 v107, v107
    v_exp_f32 v108, v108
    v_exp_f32 v109, v109
    v_smfmac_f32_32x32x32_bf16 v[64:79], v[44:47], v[96:103], v6
    s_waitcnt lgkmcnt(0)
    s_mov_b64 exec, s[34:35]
    ds_read_b128 v[48:51], v5 offset:33792
    ds_read_b128 v[56:59], v5 offset:34432
    s_mov_b64 exec, -1
    v_exp_f32 v110, v110
    v_exp_f32 v111, v111
    v_exp_f32 v112, v112
    v_exp_f32_e64 v113, v113
    v_smfmac_f32_32x32x32_bf16 v[64:79], v[52:55], v[104:111], v6
    v_exp_f32 v114, v114
    v_exp_f32 v115, v115
    v_exp_f32 v116, v116
    v_exp_f32 v117, v117
    v_mfma_f32_32x32x16_bf16 v[128:143], v[32:35], v[16:19], v[128:143]
    s_cmp_eq_u32 s38, 7
    v_exp_f32 v118, v118
    v_exp_f32 v119, v119
    v_exp_f32 v120, v120
    v_exp_f32_e64 v121, v121
    v_smfmac_f32_32x32x32_bf16 v[80:95], v[44:47], v[112:119], v6
    s_waitcnt lgkmcnt(0)
    v_exp_f32 v122, v122
    v_exp_f32 v123, v123
    v_exp_f32 v124, v124
    v_mfma_f32_32x32x16_bf16 v[144:159], v[32:35], v[20:23], v[144:159]
    v_exp_f32 v125, v125
    v_exp_f32 v126, v126
    v_exp_f32 v127, v127
    v_exp_f32 v128, v128
    v_exp_f32 v129, v129
    s_cbranch_scc1 L_nb7
    s_barrier
L_nb7:
    s_setprio 1
    v_smfmac_f32_32x32x32_bf16 v[80:95], v[52:55], v[120:127], v6
    v_add_u32 v4, s56, v4
    v_add_u32 v3, s56, v3
    ds_read_b32 v40, v4
    v_add_u32 v5, s56, v5
    ds_read_b128 v[32:35], v3 offset:0
    v_exp_f32 v130, v130
    v_exp_f32 v131, v131
    v_exp_f32 v132, v132
    v_exp_f32 v133, v133
    s_waitcnt lgkmcnt(1)
    v_mfma_f32_32x32x4_2b_bf16 v[96:127], v[40:41], v[24:25], 0 cbsz:1 abid:0
    v_exp_f32 v134, v134
    v_exp_f32 v135, v135
    v_exp_f32 v136, v136
    v_exp_f32 v137, v137
    v_exp_f32 v138, v138
    v_exp_f32 v139, v139
    v_exp_f32 v140, v140
    v_exp_f32 v141, v141
    v_smfmac_f32_32x32x32_bf16 v[64:79], v[48:51], v[128:135], v6
    s_waitcnt lgkmcnt(0)
    s_mov_b64 exec, s[34:35]
    ds_read_b128 v[44:47], v5 offset:0
    ds_read_b128 v[52:55], v5 offset:640
    s_mov_b64 exec, -1
    v_exp_f32 v142, v142
    v_exp_f32 v143, v143
    v_exp_f32 v144, v144
    v_exp_f32_e64 v145, v145
    v_smfmac_f32_32x32x32_bf16 v[64:79], v[56:59], v[136:143], v6
    s_add_u32 s38, s38, 1
    v_exp_f32 v146, v146
    v_exp_f32 v147, v147
    v_exp_f32 v148, v148
    v_exp_f32_e64 v149, v149
    v_mfma_f32_32x32x16_bf16 v[96:111], v[32:35], v[16:19], v[96:111]
    s_cmp_lt_u32 s38, 8
    v_exp_f32 v150, v150
    v_exp_f32 v151, v151
    v_exp_f32 v152, v152
    v_exp_f32_e64 v153, v153
    v_smfmac_f32_32x32x32_bf16 v[80:95], v[48:51], v[144:151], v6
    s_waitcnt lgkmcnt(0)
    v_exp_f32 v154, v154
    v_exp_f32 v155, v155
    v_exp_f32 v156, v156
    v_mfma_f32_32x32x16_bf16 v[112:127], v[32:35], v[20:23], v[112:127]
    v_exp_f32 v157, v157
    v_exp_f32 v158, v158
    v_exp_f32 v159, v159
    s_cbranch_scc1 L_loop
    s_nop 0
    v_smfmac_f32_32x32x32_bf16 v[80:95], v[56:59], v[152:159], v6
    v_mov_b32 v15, 162864
    ds_read_b32 v160, v15
L_fin:
    v_mov_b32 v10, v74
    v_mov_b32 v11, v74
    v_maximum3_f32 v14, v8, v9, v74
    v_maximum3_f32 v14, v14, |v64|, |v65|
    v_maximum3_f32 v14, v14, |v66|, |v67|
    v_permlane32_swap_b32 v10, v11
    v_maximum3_f32 v14, v14, |v68|, |v69|
    v_maximum3_f32 v14, v14, |v70|, |v71|
    v_rcp_f32 v11, v10
    v_maximum3_f32 v14, v14, |v72|, |v73|
    v_mul_f32 v26, v11, v8
    v_pk_mul_f32 v[64:65], v[64:65], v[26:27] op_sel_hi:[1,0]
    v_pk_mul_f32 v[66:67], v[66:67], v[26:27] op_sel_hi:[1,0]
    v_pk_mul_f32 v[68:69], v[68:69], v[26:27] op_sel_hi:[1,0]
    v_pk_mul_f32 v[70:71], v[70:71], v[26:27] op_sel_hi:[1,0]
    v_pk_mul_f32 v[72:73], v[72:73], v[26:27] op_sel_hi:[1,0]
    v_cvt_pk_bf16_f32 v32, v64, v65
    v_cvt_pk_bf16_f32 v33, v66, v67
    v_cvt_pk_bf16_f32 v34, v68, v69
    v_cvt_pk_bf16_f32 v35, v70, v71
    v_cvt_pk_bf16_f32 v44, v72, v73
    s_mov_b32 s32, 0x6c800000
    s_mov_b32 s33, 0x1e800000
    s_add_u32 s31, s58, 73728
    v_mov_b32 v12, v90
    v_mov_b32 v13, v90
    v_maximum3_f32 v14, v14, v90, v90
    v_maximum3_f32 v14, v14, |v80|, |v81|
    v_maximum3_f32 v14, v14, |v82|, |v83|
    v_permlane32_swap_b32 v12, v13
    v_maximum3_f32 v14, v14, |v84|, |v85|
    v_maximum3_f32 v14, v14, |v86|, |v87|
    v_rcp_f32 v13, v12
    v_maximum3_f32 v14, v14, |v88|, |v89|
    v_min_f32 v12, v12, v10
    v_cmp_nge_f32 vcc, s32, v14
    v_cmp_nle_f32 s[44:45], s33, v12
    v_mul_f32 v26, v13, v9
    v_pk_mul_f32 v[80:81], v[80:81], v[26:27] op_sel_hi:[1,0]
    v_pk_mul_f32 v[82:83], v[82:83], v[26:27] op_sel_hi:[1,0]
    v_pk_mul_f32 v[84:85], v[84:85], v[26:27] op_sel_hi:[1,0]
    v_pk_mul_f32 v[86:87], v[86:87], v[26:27] op_sel_hi:[1,0]
    v_pk_mul_f32 v[88:89], v[88:89], v[26:27] op_sel_hi:[1,0]
    v_cvt_pk_bf16_f32 v36, v80, v81
    v_cvt_pk_bf16_f32 v37, v82, v83
    v_cvt_pk_bf16_f32 v38, v84, v85
    v_cvt_pk_bf16_f32 v39, v86, v87
    v_cvt_pk_bf16_f32 v45, v88, v89
    s_or_b64 vcc, vcc, s[44:45]
    s_cbranch_vccnz L_exact
L_store:
    buffer_store_dwordx4 v[32:35], v2, s[12:15], s58 offen sc1
    v_permlane32_swap_b32 v44, v45
    buffer_store_dwordx4 v[36:39], v2, s[12:15], s31 offen sc1
    s_setprio 0
    buffer_store_dword v44, v165, s[12:15], s59 offen offset:2048 sc1
    v_mov_b32 v7, 8
    ds_write_b32 v167, v7
    s_waitcnt lgkmcnt(1)
    v_readfirstlane_b32 s57, v160
    s_nop 3
    s_lshr_b32 s68, s57, 8
    s_and_b32 s68, s68, 7
    s_and_b32 s57, s57, 0xff
    s_lshr_b32 s64, s57, 1
    s_and_b32 s65, s57, 1
    s_mul_i32 s65, s65, 3
    s_sub_u32 s32, s57, 18
    s_cmp_ge_u32 s57, 18
    s_cselect_b32 s64, s32, s64
    s_cselect_b32 s65, 6, s65
    s_add_u32 s65, s65, s66
    s_lshl_b32 s32, s68, 3
    s_add_u32 s32, s32, s65
    s_mul_i32 s69, s32, 73728
    s_mul_i32 s32, s67, 18432
    s_add_u32 s69, s69, s32
    s_add_u32 s69, s69, 11534336
L_tail:
    s_cmp_ge_u32 s57, 27
    s_cbranch_scc1 L_end
    s_cmp_ge_u32 s65, 8
    s_cbranch_scc1 L_end
    v_lshlrev_b32 v5, 2, v1
    s_mov_b32 s40, 0
    s_and_b32 s39, s67, 1
    s_mul_i32 s32, s39, 2304
    s_sub_u32 s3, s69, s32
    s_add_u32 s69, s69, s32
    v_min_u32 v12, 11, v1
    v_lshlrev_b32 v12, 2, v12
    v_add_u32 v12, 162816, v12
L_ws1:
    ds_read_b32 v13, v12
    s_waitcnt lgkmcnt(0)
    v_cmp_gt_u32 vcc, 8, v13
    s_cbranch_vccz L_go
    s_sleep 1
    s_branch L_ws1
L_go:
    s_add_u32 s32, s69, 0
    buffer_load_dwordx4 v[56:59], v2, s[12:15], s32 offen sc1
    buffer_load_dwordx4 v[60:63], v2, s[12:15], s32 offen offset:1024 sc1
    buffer_load_dword v120, v5, s[12:15], s32 offen offset:2048 sc1
    s_add_u32 s32, s69, 4608
    buffer_load_dwordx4 v[72:75], v2, s[12:15], s32 offen sc1
    buffer_load_dwordx4 v[76:79], v2, s[12:15], s32 offen offset:1024 sc1
    buffer_load_dword v122, v5, s[12:15], s32 offen offset:2048 sc1
    v_and_b32 v10, 31, v1
    v_lshrrev_b32 v11, 5, v1
    v_bfe_u32 v12, v1, 2, 2
    v_and_b32 v13, 3, v1
    v_bfe_u32 v14, v1, 4, 1
    v_lshlrev_b32 v13, 3, v13
    v_lshl_add_u32 v13, v14, 5, v13
    s_mul_i32 s32, s67, 36864
    v_add_u32 v13, s32, v13
    v_lshrrev_b32 v14, 1, v12
    v_lshl_add_u32 v6, v11, 2, v12
    v_lshl_add_u32 v6, v6, 7, v13
    v_lshl_add_u32 v3, v14, 6, v6
    s_mul_i32 s32, s39, 4608
    v_subrev_u32 v48, s32, v3
    v_xor_b32 v49, 64, v48
    v_add_u32 v3, s32, v3
    v_xor_b32 v14, s39, v14
    v_xor_b32 v4, 64, v3
    v_lshl_add_u32 v6, v14, 1, v11
    v_mul_u32_u24 v6, 18, v6
    v_and_b32 v12, 1, v12
    v_add3_u32 v6, v6, v12, 16
    v_lshl_add_u32 v6, v6, 7, v13
    v_lshl_add_u32 v8, v11, 6, v6
    v_xor_b32 v9, 64, v8
    s_mul_i32 s32, s66, 8448
    s_mul_i32 s33, s67, 36864
    s_add_u32 s30, s32, s33
    v_add_u32 v163, s30, v2
    s_lshl_b32 s33, s67, 7
    s_add_u32 s30, s32, s33
    v_and_b32 v12, 7, v1
    v_lshrrev_b32 v13, 3, v1
    v_mul_u32_u24 v164, 1056, v12
    v_lshl_add_u32 v164, v13, 4, v164
    v_add_u32 v164, s30, v164
    v_mul_u32_u24 v165, 1152, v13
    v_lshl_add_u32 v165, v12, 4, v165
    v_add_u32 v166, 73728, v164
    s_lshl_b32 s32, s23, 2
    s_add_u32 s32, s32, 162880
    v_mov_b32 v167, s32
    s_sub_u32 s32, s65, s66
    s_cmp_eq_u32 s32, 6
    s_cselect_b32 s32, 1, 2
    v_min_u32 v7, s32, v1
    s_mul_i32 s32, s67, 12
    s_add_u32 s32, s32, 162880
    v_lshlrev_b32 v7, 2, v7
    v_add_u32 v7, s32, v7
    s_lshl_b32 s32, s68, 8
    s_lshl_b32 s33, s65, 5
    s_add_u32 s32, s32, s33
    s_mul_i32 s58, s32, 1152
    s_lshl_b32 s32, s64, 7
    s_add_u32 s58, s58, s32
    s_mul_i32 s32, s67, 9216
    s_add_u32 s58, s58, s32
    v_mov_b32 v128, 0
    v_mov_b32 v129, 0
    v_mov_b32 v130, 0
    v_mov_b32 v131, 0
    v_mov_b32 v132, 0
    v_mov_b32 v133, 0
    v_mov_b32 v134, 0
    v_mov_b32 v135, 0
    v_mov_b32 v136, 0
    v_mov_b32 v137, 0
    v_mov_b32 v138, 0
    v_mov_b32 v139, 0
    v_mov_b32 v140, 0
    v_mov_b32 v141, 0
    v_mov_b32 v142, 0
    v_mov_b32 v143, 0
    v_mov_b32 v144, 0
    v_mov_b32 v145, 0
    v_mov_b32 v146, 0
    v_mov_b32 v147, 0
    v_mov_b32 v148, 0
    v_mov_b32 v149, 0
    v_mov_b32 v150, 0
    v_mov_b32 v151, 0
    v_mov_b32 v152, 0
    v_mov_b32 v153, 0
    v_mov_b32 v154, 0
    v_mov_b32 v155, 0
    v_mov_b32 v156, 0
    v_mov_b32 v157, 0
    v_mov_b32 v158, 0
    v_mov_b32 v159, 0
    ds_read_b64_tr_b16 v[16:17], v3 offset:0
    ds_read_b64_tr_b16 v[18:19], v3 offset:1024
    ds_read_b64_tr_b16 v[20:21], v4 offset:0
    ds_read_b64_tr_b16 v[22:23], v4 offset:1024
    ds_read_b64_tr_b16 v[24:25], v4 offset:2304
    ds_read_b64_tr_b16 v[26:27], v4 offset:3328
    ds_read_b64_tr_b16 v[28:29], v3 offset:2304
    ds_read_b64_tr_b16 v[30:31], v3 offset:3328
    s_waitcnt vmcnt(3) lgkmcnt(0)
    ds_read_b64_tr_b16 v[32:33], v3 offset:9216
    ds_read_b64_tr_b16 v[34:35], v3 offset:10240
    ds_read_b64_tr_b16 v[36:37], v4 offset:9216
    ds_read_b64_tr_b16 v[38:39], v4 offset:10240
    ds_read_b64_tr_b16 v[40:41], v4 offset:11520
    ds_read_b64_tr_b16 v[42:43], v4 offset:12544
    ds_read_b64_tr_b16 v[44:45], v3 offset:11520
    ds_read_b64_tr_b16 v[46:47], v3 offset:12544
    v_max3_u32 v12, v56, v57, v58
    v_max3_u32 v13, v59, v60, v61
    v_max3_u32 v12, v12, v62, v63
    v_max3_u32 v12, v12, v13, v120
    v_cmp_eq_u32 vcc, -1, v12
    s_cbranch_vccnz L_s0
    s_bitset1_b32 s40, 0
    v_mfma_f32_32x32x16_bf16 v[128:143], v[16:19], v[56:59], v[128:143]
    v_mfma_f32_32x32x16_bf16 v[144:159], v[20:23], v[56:59], v[144:159]
    v_mfma_f32_32x32x16_bf16 v[128:143], v[24:27], v[60:63], v[128:143]
    v_mfma_f32_32x32x16_bf16 v[144:159], v[28:31], v[60:63], v[144:159]
L_s0:
    s_add_u32 s32, s69, 9216
    buffer_load_dwordx4 v[88:91], v2, s[12:15], s32 offen sc1
    buffer_load_dwordx4 v[92:95], v2, s[12:15], s32 offen offset:1024 sc1
    buffer_load_dword v124, v5, s[12:15], s32 offen offset:2048 sc1
    s_waitcnt vmcnt(3) lgkmcnt(0)
    ds_read_b64_tr_b16 v[16:17], v3 offset:18432
    ds_read_b64_tr_b16 v[18:19], v3 offset:19456
    ds_read_b64_tr_b16 v[20:21], v4 offset:18432
    ds_read_b64_tr_b16 v[22:23], v4 offset:19456
    ds_read_b64_tr_b16 v[24:25], v4 offset:20736
    ds_read_b64_tr_b16 v[26:27], v4 offset:21760
    ds_read_b64_tr_b16 v[28:29], v3 offset:20736
    ds_read_b64_tr_b16 v[30:31], v3 offset:21760
    v_max3_u32 v12, v72, v73, v74
    v_max3_u32 v13, v75, v76, v77
    v_max3_u32 v12, v12, v78, v79
    v_max3_u32 v12, v12, v13, v122
    v_cmp_eq_u32 vcc, -1, v12
    s_cbranch_vccnz L_s1
    s_bitset1_b32 s40, 2
    v_mfma_f32_32x32x16_bf16 v[128:143], v[32:35], v[72:75], v[128:143]
    v_mfma_f32_32x32x16_bf16 v[144:159], v[36:39], v[72:75], v[144:159]
    v_mfma_f32_32x32x16_bf16 v[128:143], v[40:43], v[76:79], v[128:143]
    v_mfma_f32_32x32x16_bf16 v[144:159], v[44:47], v[76:79], v[144:159]
L_s1:
    s_add_u32 s32, s69, 13824
    buffer_load_dwordx4 v[104:107], v2, s[12:15], s32 offen sc1
    buffer_load_dwordx4 v[108:111], v2, s[12:15], s32 offen offset:1024 sc1
    buffer_load_dword v126, v5, s[12:15], s32 offen offset:2048 sc1
    s_waitcnt vmcnt(3) lgkmcnt(0)
    ds_read_b64_tr_b16 v[32:33], v3 offset:27648
    ds_read_b64_tr_b16 v[34:35], v3 offset:28672
    ds_read_b64_tr_b16 v[36:37], v4 offset:27648
    ds_read_b64_tr_b16 v[38:39], v4 offset:28672
    ds_read_b64_tr_b16 v[40:41], v4 offset:29952
    ds_read_b64_tr_b16 v[42:43], v4 offset:30976
    ds_read_b64_tr_b16 v[44:45], v3 offset:29952
    ds_read_b64_tr_b16 v[46:47], v3 offset:30976
    v_max3_u32 v12, v88, v89, v90
    v_max3_u32 v13, v91, v92, v93
    v_max3_u32 v12, v12, v94, v95
    v_max3_u32 v12, v12, v13, v124
    v_cmp_eq_u32 vcc, -1, v12
    s_cbranch_vccnz L_s2
    s_bitset1_b32 s40, 4
    v_mfma_f32_32x32x16_bf16 v[128:143], v[16:19], v[88:91], v[128:143]
    v_mfma_f32_32x32x16_bf16 v[144:159], v[20:23], v[88:91], v[144:159]
    v_mfma_f32_32x32x16_bf16 v[128:143], v[24:27], v[92:95], v[128:143]
    v_mfma_f32_32x32x16_bf16 v[144:159], v[28:31], v[92:95], v[144:159]
L_s2:
    s_add_u32 s32, s3, 2304
    buffer_load_dwordx4 v[64:67], v2, s[12:15], s32 offen sc1
    buffer_load_dwordx4 v[68:71], v2, s[12:15], s32 offen offset:1024 sc1
    buffer_load_dword v121, v5, s[12:15], s32 offen offset:2048 sc1
    s_waitcnt vmcnt(3) lgkmcnt(0)
    ds_read_b64_tr_b16 v[16:17], v48 offset:4608
    ds_read_b64_tr_b16 v[18:19], v48 offset:5632
    ds_read_b64_tr_b16 v[20:21], v49 offset:4608
    ds_read_b64_tr_b16 v[22:23], v49 offset:5632
    ds_read_b64_tr_b16 v[24:25], v49 offset:6912
    ds_read_b64_tr_b16 v[26:27], v49 offset:7936
    ds_read_b64_tr_b16 v[28:29], v48 offset:6912
    ds_read_b64_tr_b16 v[30:31], v48 offset:7936
    v_max3_u32 v12, v104, v105, v106
    v_max3_u32 v13, v107, v108, v109
    v_max3_u32 v12, v12, v110, v111
    v_max3_u32 v12, v12, v13, v126
    v_cmp_eq_u32 vcc, -1, v12
    s_cbranch_vccnz L_s3
    s_bitset1_b32 s40, 6
    v_mfma_f32_32x32x16_bf16 v[128:143], v[32:35], v[104:107], v[128:143]
    v_mfma_f32_32x32x16_bf16 v[144:159], v[36:39], v[104:107], v[144:159]
    v_mfma_f32_32x32x16_bf16 v[128:143], v[40:43], v[108:111], v[128:143]
    v_mfma_f32_32x32x16_bf16 v[144:159], v[44:47], v[108:111], v[144:159]
L_s3:
    s_add_u32 s32, s3, 6912
    buffer_load_dwordx4 v[80:83], v2, s[12:15], s32 offen sc1
    buffer_load_dwordx4 v[84:87], v2, s[12:15], s32 offen offset:1024 sc1
    buffer_load_dword v123, v5, s[12:15], s32 offen offset:2048 sc1
    s_waitcnt vmcnt(3) lgkmcnt(0)
    ds_read_b64_tr_b16 v[32:33], v48 offset:13824
    ds_read_b64_tr_b16 v[34:35], v48 offset:14848
    ds_read_b64_tr_b16 v[36:37], v49 offset:13824
    ds_read_b64_tr_b16 v[38:39], v49 offset:14848
    ds_read_b64_tr_b16 v[40:41], v49 offset:16128
    ds_read_b64_tr_b16 v[42:43], v49 offset:17152
    ds_read_b64_tr_b16 v[44:45], v48 offset:16128
    ds_read_b64_tr_b16 v[46:47], v48 offset:17152
    v_max3_u32 v12, v64, v65, v66
    v_max3_u32 v13, v67, v68, v69
    v_max3_u32 v12, v12, v70, v71
    v_max3_u32 v12, v12, v13, v121
    v_cmp_eq_u32 vcc, -1, v12
    s_cbranch_vccnz L_s4
    s_bitset1_b32 s40, 1
    v_mfma_f32_32x32x16_bf16 v[128:143], v[16:19], v[64:67], v[128:143]
    v_mfma_f32_32x32x16_bf16 v[144:159], v[20:23], v[64:67], v[144:159]
    v_mfma_f32_32x32x16_bf16 v[128:143], v[24:27], v[68:71], v[128:143]
    v_mfma_f32_32x32x16_bf16 v[144:159], v[28:31], v[68:71], v[144:159]
L_s4:
    s_add_u32 s32, s3, 11520
    buffer_load_dwordx4 v[96:99], v2, s[12:15], s32 offen sc1
    buffer_load_dwordx4 v[100:103], v2, s[12:15], s32 offen offset:1024 sc1
    buffer_load_dword v125, v5, s[12:15], s32 offen offset:2048 sc1
    s_waitcnt vmcnt(3) lgkmcnt(0)
    ds_read_b64_tr_b16 v[16:17], v48 offset:23040
    ds_read_b64_tr_b16 v[18:19], v48 offset:24064
    ds_read_b64_tr_b16 v[20:21], v49 offset:23040
    ds_read_b64_tr_b16 v[22:23], v49 offset:24064
    ds_read_b64_tr_b16 v[24:25], v49 offset:25344
    ds_read_b64_tr_b16 v[26:27], v49 offset:26368
    ds_read_b64_tr_b16 v[28:29], v48 offset:25344
    ds_read_b64_tr_b16 v[30:31], v48 offset:26368
    v_max3_u32 v12, v80, v81, v82
    v_max3_u32 v13, v83, v84, v85
    v_max3_u32 v12, v12, v86, v87
    v_max3_u32 v12, v12, v13, v123
    v_cmp_eq_u32 vcc, -1, v12
    s_cbranch_vccnz L_s5
    s_bitset1_b32 s40, 3
    v_mfma_f32_32x32x16_bf16 v[128:143], v[32:35], v[80:83], v[128:143]
    v_mfma_f32_32x32x16_bf16 v[144:159], v[36:39], v[80:83], v[144:159]
    v_mfma_f32_32x32x16_bf16 v[128:143], v[40:43], v[84:87], v[128:143]
    v_mfma_f32_32x32x16_bf16 v[144:159], v[44:47], v[84:87], v[144:159]
L_s5:
    s_add_u32 s32, s3, 16128
    buffer_load_dwordx4 v[112:115], v2, s[12:15], s32 offen sc1
    buffer_load_dwordx4 v[116:119], v2, s[12:15], s32 offen offset:1024 sc1
    buffer_load_dword v127, v5, s[12:15], s32 offen offset:2048 sc1
    s_waitcnt vmcnt(3) lgkmcnt(0)
    ds_read_b64_tr_b16 v[32:33], v48 offset:32256
    ds_read_b64_tr_b16 v[34:35], v48 offset:33280
    ds_read_b64_tr_b16 v[36:37], v49 offset:32256
    ds_read_b64_tr_b16 v[38:39], v49 offset:33280
    ds_read_b64_tr_b16 v[40:41], v49 offset:34560
    ds_read_b64_tr_b16 v[42:43], v49 offset:35584
    ds_read_b64_tr_b16 v[44:45], v48 offset:34560
    ds_read_b64_tr_b16 v[46:47], v48 offset:35584
    v_max3_u32 v12, v96, v97, v98
    v_max3_u32 v13, v99, v100, v101
    v_max3_u32 v12, v12, v102, v103
    v_max3_u32 v12, v12, v13, v125
    v_cmp_eq_u32 vcc, -1, v12
    s_cbranch_vccnz L_s6
    s_bitset1_b32 s40, 5
    v_mfma_f32_32x32x16_bf16 v[128:143], v[16:19], v[96:99], v[128:143]
    v_mfma_f32_32x32x16_bf16 v[144:159], v[20:23], v[96:99], v[144:159]
    v_mfma_f32_32x32x16_bf16 v[128:143], v[24:27], v[100:103], v[128:143]
    v_mfma_f32_32x32x16_bf16 v[144:159], v[28:31], v[100:103], v[144:159]
L_s6:
    s_waitcnt vmcnt(0) lgkmcnt(0)
    ds_read_b64_tr_b16 v[16:17], v8 offset:0
    ds_read_b64_tr_b16 v[18:19], v8 offset:9216
    ds_read_b64_tr_b16 v[20:21], v9 offset:0
    ds_read_b64_tr_b16 v[22:23], v9 offset:9216
    ds_read_b64_tr_b16 v[24:25], v8 offset:18432
    ds_read_b64_tr_b16 v[26:27], v8 offset:27648
    ds_read_b64_tr_b16 v[28:29], v9 offset:18432
    ds_read_b64_tr_b16 v[30:31], v9 offset:27648
    v_max3_u32 v12, v112, v113, v114
    v_max3_u32 v13, v115, v116, v117
    v_max3_u32 v12, v12, v118, v119
    v_max3_u32 v12, v12, v13, v127
    v_cmp_eq_u32 vcc, -1, v12
    s_cbranch_vccnz L_s7
    s_bitset1_b32 s40, 7
    v_mfma_f32_32x32x16_bf16 v[128:143], v[32:35], v[112:115], v[128:143]
    v_mfma_f32_32x32x16_bf16 v[144:159], v[36:39], v[112:115], v[144:159]
    v_mfma_f32_32x32x16_bf16 v[128:143], v[40:43], v[116:119], v[128:143]
    v_mfma_f32_32x32x16_bf16 v[144:159], v[44:47], v[116:119], v[144:159]
L_s7:
L_chk:
    s_cmp_eq_u32 s40, 0xff
    s_cbranch_scc0 L_round
L_hi:
    v_mov_b32 v12, 1
    s_waitcnt lgkmcnt(0)
    ds_write_b32 v167, v12
    v_mfma_f32_32x32x16_bf16 v[128:143], v[16:19], v[120:123], v[128:143]
    v_mfma_f32_32x32x16_bf16 v[144:159], v[20:23], v[120:123], v[144:159]
    v_mfma_f32_32x32x16_bf16 v[128:143], v[24:27], v[124:127], v[128:143]
    v_mfma_f32_32x32x16_bf16 v[144:159], v[28:31], v[124:127], v[144:159]
L_qs:
    ds_read_b32 v13, v7
    s_waitcnt lgkmcnt(0)
    v_cmp_eq_u32 vcc, 0, v13
    s_cbranch_vccnz L_qs
    s_nop 6
    ds_write_b128 v163, v[128:131] offset:0
    ds_write_b128 v163, v[132:135] offset:1056
    ds_write_b128 v163, v[136:139] offset:2112
    ds_write_b128 v163, v[140:143] offset:3168
    ds_write_b128 v163, v[144:147] offset:4224
    ds_write_b128 v163, v[148:151] offset:5280
    ds_write_b128 v163, v[152:155] offset:6336
    ds_write_b128 v163, v[156:159] offset:7392
    s_waitcnt lgkmcnt(0)
    s_barrier
    ds_read_b128 v[56:59], v164 offset:0
    ds_read_b128 v[60:63], v164 offset:512
    ds_read_b128 v[64:67], v164 offset:36864
    ds_read_b128 v[68:71], v164 offset:37376
    ds_read_b128 v[72:75], v166 offset:0
    ds_read_b128 v[76:79], v166 offset:512
    ds_read_b128 v[80:83], v166 offset:36864
    ds_read_b128 v[84:87], v166 offset:37376
    s_waitcnt lgkmcnt(4)
    v_add_f32 v56, v56, v64
    v_add_f32 v57, v57, v65
    v_add_f32 v58, v58, v66
    v_add_f32 v59, v59, v67
    v_add_f32 v60, v60, v68
    v_add_f32 v61, v61, v69
    v_add_f32 v62, v62, v70
    v_add_f32 v63, v63, v71
    s_waitcnt lgkmcnt(0)
    v_add_f32 v72, v72, v80
    v_add_f32 v73, v73, v81
    v_add_f32 v74, v74, v82
    v_add_f32 v75, v75, v83
    v_add_f32 v76, v76, v84
    v_add_f32 v77, v77, v85
    v_add_f32 v78, v78, v86
    v_add_f32 v79, v79, v87
    v_add_f32 v56, v56, v72
    v_add_f32 v57, v57, v73
    v_add_f32 v58, v58, v74
    v_add_f32 v59, v59, v75
    v_add_f32 v60, v60, v76
    v_add_f32 v61, v61, v77
    v_add_f32 v62, v62, v78
    v_add_f32 v63, v63, v79
    v_cvt_pk_bf16_f32 v16, v56, v57
    v_cvt_pk_bf16_f32 v17, v58, v59
    v_cvt_pk_bf16_f32 v18, v60, v61
    v_cvt_pk_bf16_f32 v19, v62, v63
    buffer_store_dwordx4 v[16:19], v165, s[16:19], s58 offen sc1
    s_branch L_end
L_round:
    s_sub_u32 s63, s63, 1
    s_cbranch_scc1 L_hi
    s_not_b32 s42, s40
    s_bitcmp1_b32 s42, 0
    s_cbranch_scc0 L_ni0
    s_add_u32 s32, s69, 0
    buffer_load_dwordx4 v[56:59], v2, s[12:15], s32 offen sc1
    buffer_load_dwordx4 v[60:63], v2, s[12:15], s32 offen offset:1024 sc1
    buffer_load_dword v120, v5, s[12:15], s32 offen offset:2048 sc1
L_ni0:
    s_bitcmp1_b32 s42, 1
    s_cbranch_scc0 L_ni1
    s_add_u32 s32, s3, 2304
    buffer_load_dwordx4 v[64:67], v2, s[12:15], s32 offen sc1
    buffer_load_dwordx4 v[68:71], v2, s[12:15], s32 offen offset:1024 sc1
    buffer_load_dword v121, v5, s[12:15], s32 offen offset:2048 sc1
L_ni1:
    s_bitcmp1_b32 s42, 2
    s_cbranch_scc0 L_ni2
    s_add_u32 s32, s69, 4608
    buffer_load_dwordx4 v[72:75], v2, s[12:15], s32 offen sc1
    buffer_load_dwordx4 v[76:79], v2, s[12:15], s32 offen offset:1024 sc1
    buffer_load_dword v122, v5, s[12:15], s32 offen offset:2048 sc1
L_ni2:
    s_bitcmp1_b32 s42, 3
    s_cbranch_scc0 L_ni3
    s_add_u32 s32, s3, 6912
    buffer_load_dwordx4 v[80:83], v2, s[12:15], s32 offen sc1
    buffer_load_dwordx4 v[84:87], v2, s[12:15], s32 offen offset:1024 sc1
    buffer_load_dword v123, v5, s[12:15], s32 offen offset:2048 sc1
L_ni3:
    s_bitcmp1_b32 s42, 4
    s_cbranch_scc0 L_ni4
    s_add_u32 s32, s69, 9216
    buffer_load_dwordx4 v[88:91], v2, s[12:15], s32 offen sc1
    buffer_load_dwordx4 v[92:95], v2, s[12:15], s32 offen offset:1024 sc1
    buffer_load_dword v124, v5, s[12:15], s32 offen offset:2048 sc1
L_ni4:
    s_bitcmp1_b32 s42, 5
    s_cbranch_scc0 L_ni5
    s_add_u32 s32, s3, 11520
    buffer_load_dwordx4 v[96:99], v2, s[12:15], s32 offen sc1
    buffer_load_dwordx4 v[100:103], v2, s[12:15], s32 offen offset:1024 sc1
    buffer_load_dword v125, v5, s[12:15], s32 offen offset:2048 sc1
L_ni5:
    s_bitcmp1_b32 s42, 6
    s_cbranch_scc0 L_ni6
    s_add_u32 s32, s69, 13824
    buffer_load_dwordx4 v[104:107], v2, s[12:15], s32 offen sc1
    buffer_load_dwordx4 v[108:111], v2, s[12:15], s32 offen offset:1024 sc1
    buffer_load_dword v126, v5, s[12:15], s32 offen offset:2048 sc1
L_ni6:
    s_bitcmp1_b32 s42, 7
    s_cbranch_scc0 L_ni7
    s_add_u32 s32, s3, 16128
    buffer_load_dwordx4 v[112:115], v2, s[12:15], s32 offen sc1
    buffer_load_dwordx4 v[116:119], v2, s[12:15], s32 offen offset:1024 sc1
    buffer_load_dword v127, v5, s[12:15], s32 offen offset:2048 sc1
L_ni7:
    s_bitcmp1_b32 s42, 0
    s_cbranch_scc0 L_nc0
    ds_read_b64_tr_b16 v[32:33], v3 offset:0
    ds_read_b64_tr_b16 v[34:35], v3 offset:1024
    ds_read_b64_tr_b16 v[36:37], v4 offset:0
    ds_read_b64_tr_b16 v[38:39], v4 offset:1024
    ds_read_b64_tr_b16 v[40:41], v4 offset:2304
    ds_read_b64_tr_b16 v[42:43], v4 offset:3328
    ds_read_b64_tr_b16 v[44:45], v3 offset:2304
    ds_read_b64_tr_b16 v[46:47], v3 offset:3328
    s_waitcnt vmcnt(0)
    v_max3_u32 v12, v56, v57, v58
    v_max3_u32 v13, v59, v60, v61
    v_max3_u32 v12, v12, v62, v63
    v_max3_u32 v12, v12, v13, v120
    v_cmp_eq_u32 vcc, -1, v12
    s_cbranch_vccnz L_nc0
    s_bitset1_b32 s40, 0
    s_waitcnt lgkmcnt(0)
    v_mfma_f32_32x32x16_bf16 v[128:143], v[32:35], v[56:59], v[128:143]
    v_mfma_f32_32x32x16_bf16 v[144:159], v[36:39], v[56:59], v[144:159]
    v_mfma_f32_32x32x16_bf16 v[128:143], v[40:43], v[60:63], v[128:143]
    v_mfma_f32_32x32x16_bf16 v[144:159], v[44:47], v[60:63], v[144:159]
L_nc0:
    s_bitcmp1_b32 s42, 1
    s_cbranch_scc0 L_nc1
    ds_read_b64_tr_b16 v[32:33], v48 offset:4608
    ds_read_b64_tr_b16 v[34:35], v48 offset:5632
    ds_read_b64_tr_b16 v[36:37], v49 offset:4608
    ds_read_b64_tr_b16 v[38:39], v49 offset:5632
    ds_read_b64_tr_b16 v[40:41], v49 offset:6912
    ds_read_b64_tr_b16 v[42:43], v49 offset:7936
    ds_read_b64_tr_b16 v[44:45], v48 offset:6912
    ds_read_b64_tr_b16 v[46:47], v48 offset:7936
    s_waitcnt vmcnt(0)
    v_max3_u32 v12, v64, v65, v66
    v_max3_u32 v13, v67, v68, v69
    v_max3_u32 v12, v12, v70, v71
    v_max3_u32 v12, v12, v13, v121
    v_cmp_eq_u32 vcc, -1, v12
    s_cbranch_vccnz L_nc1
    s_bitset1_b32 s40, 1
    s_waitcnt lgkmcnt(0)
    v_mfma_f32_32x32x16_bf16 v[128:143], v[32:35], v[64:67], v[128:143]
    v_mfma_f32_32x32x16_bf16 v[144:159], v[36:39], v[64:67], v[144:159]
    v_mfma_f32_32x32x16_bf16 v[128:143], v[40:43], v[68:71], v[128:143]
    v_mfma_f32_32x32x16_bf16 v[144:159], v[44:47], v[68:71], v[144:159]
L_nc1:
    s_bitcmp1_b32 s42, 2
    s_cbranch_scc0 L_nc2
    ds_read_b64_tr_b16 v[32:33], v3 offset:9216
    ds_read_b64_tr_b16 v[34:35], v3 offset:10240
    ds_read_b64_tr_b16 v[36:37], v4 offset:9216
    ds_read_b64_tr_b16 v[38:39], v4 offset:10240
    ds_read_b64_tr_b16 v[40:41], v4 offset:11520
    ds_read_b64_tr_b16 v[42:43], v4 offset:12544
    ds_read_b64_tr_b16 v[44:45], v3 offset:11520
    ds_read_b64_tr_b16 v[46:47], v3 offset:12544
    s_waitcnt vmcnt(0)
    v_max3_u32 v12, v72, v73, v74
    v_max3_u32 v13, v75, v76, v77
    v_max3_u32 v12, v12, v78, v79
    v_max3_u32 v12, v12, v13, v122
    v_cmp_eq_u32 vcc, -1, v12
    s_cbranch_vccnz L_nc2
    s_bitset1_b32 s40, 2
    s_waitcnt lgkmcnt(0)
    v_mfma_f32_32x32x16_bf16 v[128:143], v[32:35], v[72:75], v[128:143]
    v_mfma_f32_32x32x16_bf16 v[144:159], v[36:39], v[72:75], v[144:159]
    v_mfma_f32_32x32x16_bf16 v[128:143], v[40:43], v[76:79], v[128:143]
    v_mfma_f32_32x32x16_bf16 v[144:159], v[44:47], v[76:79], v[144:159]
L_nc2:
    s_bitcmp1_b32 s42, 3
    s_cbranch_scc0 L_nc3
    ds_read_b64_tr_b16 v[32:33], v48 offset:13824
    ds_read_b64_tr_b16 v[34:35], v48 offset:14848
    ds_read_b64_tr_b16 v[36:37], v49 offset:13824
    ds_read_b64_tr_b16 v[38:39], v49 offset:14848
    ds_read_b64_tr_b16 v[40:41], v49 offset:16128
    ds_read_b64_tr_b16 v[42:43], v49 offset:17152
    ds_read_b64_tr_b16 v[44:45], v48 offset:16128
    ds_read_b64_tr_b16 v[46:47], v48 offset:17152
    s_waitcnt vmcnt(0)
    v_max3_u32 v12, v80, v81, v82
    v_max3_u32 v13, v83, v84, v85
    v_max3_u32 v12, v12, v86, v87
    v_max3_u32 v12, v12, v13, v123
    v_cmp_eq_u32 vcc, -1, v12
    s_cbranch_vccnz L_nc3
    s_bitset1_b32 s40, 3
    s_waitcnt lgkmcnt(0)
    v_mfma_f32_32x32x16_bf16 v[128:143], v[32:35], v[80:83], v[128:143]
    v_mfma_f32_32x32x16_bf16 v[144:159], v[36:39], v[80:83], v[144:159]
    v_mfma_f32_32x32x16_bf16 v[128:143], v[40:43], v[84:87], v[128:143]
    v_mfma_f32_32x32x16_bf16 v[144:159], v[44:47], v[84:87], v[144:159]
L_nc3:
    s_bitcmp1_b32 s42, 4
    s_cbranch_scc0 L_nc4
    ds_read_b64_tr_b16 v[32:33], v3 offset:18432
    ds_read_b64_tr_b16 v[34:35], v3 offset:19456
    ds_read_b64_tr_b16 v[36:37], v4 offset:18432
    ds_read_b64_tr_b16 v[38:39], v4 offset:19456
    ds_read_b64_tr_b16 v[40:41], v4 offset:20736
    ds_read_b64_tr_b16 v[42:43], v4 offset:21760
    ds_read_b64_tr_b16 v[44:45], v3 offset:20736
    ds_read_b64_tr_b16 v[46:47], v3 offset:21760
    s_waitcnt vmcnt(0)
    v_max3_u32 v12, v88, v89, v90
    v_max3_u32 v13, v91, v92, v93
    v_max3_u32 v12, v12, v94, v95
    v_max3_u32 v12, v12, v13, v124
    v_cmp_eq_u32 vcc, -1, v12
    s_cbranch_vccnz L_nc4
    s_bitset1_b32 s40, 4
    s_waitcnt lgkmcnt(0)
    v_mfma_f32_32x32x16_bf16 v[128:143], v[32:35], v[88:91], v[128:143]
    v_mfma_f32_32x32x16_bf16 v[144:159], v[36:39], v[88:91], v[144:159]
    v_mfma_f32_32x32x16_bf16 v[128:143], v[40:43], v[92:95], v[128:143]
    v_mfma_f32_32x32x16_bf16 v[144:159], v[44:47], v[92:95], v[144:159]
L_nc4:
    s_bitcmp1_b32 s42, 5
    s_cbranch_scc0 L_nc5
    ds_read_b64_tr_b16 v[32:33], v48 offset:23040
    ds_read_b64_tr_b16 v[34:35], v48 offset:24064
    ds_read_b64_tr_b16 v[36:37], v49 offset:23040
    ds_read_b64_tr_b16 v[38:39], v49 offset:24064
    ds_read_b64_tr_b16 v[40:41], v49 offset:25344
    ds_read_b64_tr_b16 v[42:43], v49 offset:26368
    ds_read_b64_tr_b16 v[44:45], v48 offset:25344
    ds_read_b64_tr_b16 v[46:47], v48 offset:26368
    s_waitcnt vmcnt(0)
    v_max3_u32 v12, v96, v97, v98
    v_max3_u32 v13, v99, v100, v101
    v_max3_u32 v12, v12, v102, v103
    v_max3_u32 v12, v12, v13, v125
    v_cmp_eq_u32 vcc, -1, v12
    s_cbranch_vccnz L_nc5
    s_bitset1_b32 s40, 5
    s_waitcnt lgkmcnt(0)
    v_mfma_f32_32x32x16_bf16 v[128:143], v[32:35], v[96:99], v[128:143]
    v_mfma_f32_32x32x16_bf16 v[144:159], v[36:39], v[96:99], v[144:159]
    v_mfma_f32_32x32x16_bf16 v[128:143], v[40:43], v[100:103], v[128:143]
    v_mfma_f32_32x32x16_bf16 v[144:159], v[44:47], v[100:103], v[144:159]
L_nc5:
    s_bitcmp1_b32 s42, 6
    s_cbranch_scc0 L_nc6
    ds_read_b64_tr_b16 v[32:33], v3 offset:27648
    ds_read_b64_tr_b16 v[34:35], v3 offset:28672
    ds_read_b64_tr_b16 v[36:37], v4 offset:27648
    ds_read_b64_tr_b16 v[38:39], v4 offset:28672
    ds_read_b64_tr_b16 v[40:41], v4 offset:29952
    ds_read_b64_tr_b16 v[42:43], v4 offset:30976
    ds_read_b64_tr_b16 v[44:45], v3 offset:29952
    ds_read_b64_tr_b16 v[46:47], v3 offset:30976
    s_waitcnt vmcnt(0)
    v_max3_u32 v12, v104, v105, v106
    v_max3_u32 v13, v107, v108, v109
    v_max3_u32 v12, v12, v110, v111
    v_max3_u32 v12, v12, v13, v126
    v_cmp_eq_u32 vcc, -1, v12
    s_cbranch_vccnz L_nc6
    s_bitset1_b32 s40, 6
    s_waitcnt lgkmcnt(0)
    v_mfma_f32_32x32x16_bf16 v[128:143], v[32:35], v[104:107], v[128:143]
    v_mfma_f32_32x32x16_bf16 v[144:159], v[36:39], v[104:107], v[144:159]
    v_mfma_f32_32x32x16_bf16 v[128:143], v[40:43], v[108:111], v[128:143]
    v_mfma_f32_32x32x16_bf16 v[144:159], v[44:47], v[108:111], v[144:159]
L_nc6:
    s_bitcmp1_b32 s42, 7
    s_cbranch_scc0 L_nc7
    ds_read_b64_tr_b16 v[32:33], v48 offset:32256
    ds_read_b64_tr_b16 v[34:35], v48 offset:33280
    ds_read_b64_tr_b16 v[36:37], v49 offset:32256
    ds_read_b64_tr_b16 v[38:39], v49 offset:33280
    ds_read_b64_tr_b16 v[40:41], v49 offset:34560
    ds_read_b64_tr_b16 v[42:43], v49 offset:35584
    ds_read_b64_tr_b16 v[44:45], v48 offset:34560
    ds_read_b64_tr_b16 v[46:47], v48 offset:35584
    s_waitcnt vmcnt(0)
    v_max3_u32 v12, v112, v113, v114
    v_max3_u32 v13, v115, v116, v117
    v_max3_u32 v12, v12, v118, v119
    v_max3_u32 v12, v12, v13, v127
    v_cmp_eq_u32 vcc, -1, v12
    s_cbranch_vccnz L_nc7
    s_bitset1_b32 s40, 7
    s_waitcnt lgkmcnt(0)
    v_mfma_f32_32x32x16_bf16 v[128:143], v[32:35], v[112:115], v[128:143]
    v_mfma_f32_32x32x16_bf16 v[144:159], v[36:39], v[112:115], v[144:159]
    v_mfma_f32_32x32x16_bf16 v[128:143], v[40:43], v[116:119], v[128:143]
    v_mfma_f32_32x32x16_bf16 v[144:159], v[44:47], v[116:119], v[144:159]
L_nc7:
    s_branch L_chk
L_exact:
    s_cmp_eq_u32 s62, 0
    s_cbranch_scc1 L_exact1
    v_min_u32 v32, -2, v32
    v_min_u32 v33, -2, v33
    v_min_u32 v34, -2, v34
    v_min_u32 v35, -2, v35
    v_min_u32 v36, -2, v36
    v_min_u32 v37, -2, v37
    v_min_u32 v38, -2, v38
    v_min_u32 v39, -2, v39
    v_min_u32 v44, -2, v44
    v_min_u32 v45, -2, v45
    s_nop 0
    s_branch L_store
L_exact1:
    s_mov_b32 s62, 1
    v_mov_b32 v25, 0
    v_and_b32 v4, 31, v1
    v_mov_b32 v12, 4
    v_cmp_gt_u32 vcc, 19, v4
    v_mov_b32 v13, 19
    v_lshrrev_b32 v14, 5, v1
    v_cndmask_b32 v12, v12, v4, vcc
    v_cmp_eq_u32 vcc, 4, v4
    v_mul_u32_u24 v14, 320, v14
    v_lshlrev_b32 v4, 2, v4
    v_cndmask_b32 v12, v12, v13, vcc
    v_lshl_add_u32 v5, v12, 4, v14
    v_mov_b32 v10, 0xff800000
    v_mov_b32 v11, 0xff800000
    v_mov_b32 v64, 0
    v_mov_b32 v65, 0
    v_mov_b32 v66, 0
    v_mov_b32 v67, 0
    v_mov_b32 v68, 0
    v_mov_b32 v69, 0
    v_mov_b32 v70, 0
    v_mov_b32 v71, 0
    v_mov_b32 v72, 0
    v_mov_b32 v73, 0
    v_mov_b32 v74, 0
    v_mov_b32 v75, 0
    v_mov_b32 v76, 0
    v_mov_b32 v77, 0
    v_mov_b32 v78, 0
    v_mov_b32 v79, 0
    v_mov_b32 v80, 0
    v_mov_b32 v81, 0
    v_mov_b32 v82, 0
    v_mov_b32 v83, 0
    v_mov_b32 v84, 0
    v_mov_b32 v85, 0
    v_mov_b32 v86, 0
    v_mov_b32 v87, 0
    v_mov_b32 v88, 0
    v_mov_b32 v89, 0
    v_mov_b32 v90, 0
    v_mov_b32 v91, 0
    v_mov_b32 v92, 0
    v_mov_b32 v93, 0
    v_mov_b32 v94, 0
    v_mov_b32 v95, 0
    s_mov_b32 s38, 0
L_x0:
    s_lshr_b32 s32, s38, 1
    s_mul_i32 s32, s32, 9728
    s_add_u32 s32, s32, s36
    s_and_b32 s33, s38, 1
    s_mul_i32 s31, s33, 4608
    s_add_u32 s31, s31, s32
    s_lshl_b32 s30, s24, 10
    s_add_u32 s30, s30, s31
    buffer_load_dwordx4 v[32:35], v2, s[12:15], s30 offen offset:512 sc1
    s_lshl_b32 s30, s33, 7
    s_add_u32 s30, s30, s32
    s_lshl_b32 s33, s24, 8
    s_add_u32 s30, s30, s33
    buffer_load_dword v40, v4, s[12:15], s30 offen sc1
    s_waitcnt vmcnt(0)
    v_mfma_f32_32x32x4_2b_bf16 v[96:127], v[40:41], v[24:25], 0 cbsz:1 abid:0
    s_nop 15
    s_nop 3
    v_mfma_f32_32x32x16_bf16 v[96:111], v[32:35], v[16:19], v[96:111]
    v_mfma_f32_32x32x16_bf16 v[112:127], v[32:35], v[20:23], v[112:127]
    s_nop 15
    v_max3_f32 v10, v10, v96, v97
    v_max3_f32 v10, v10, v98, v99
    v_max3_f32 v10, v10, v100, v101
    v_max3_f32 v10, v10, v102, v103
    v_max3_f32 v10, v10, v104, v105
    v_max3_f32 v10, v10, v106, v107
    v_max3_f32 v10, v10, v108, v109
    v_max3_f32 v10, v10, v110, v111
    v_max3_f32 v11, v11, v112, v113
    v_max3_f32 v11, v11, v114, v115
    v_max3_f32 v11, v11, v116, v117
    v_max3_f32 v11, v11, v118, v119
    v_max3_f32 v11, v11, v120, v121
    v_max3_f32 v11, v11, v122, v123
    v_max3_f32 v11, v11, v124, v125
    v_max3_f32 v11, v11, v126, v127
    s_add_u32 s38, s38, 1
    s_cmp_lt_u32 s38, 64
    s_cbranch_scc1 L_x0
    v_mov_b32 v12, v10
    v_mov_b32 v13, v11
    s_nop 1
    v_permlane32_swap_b32 v10, v12
    v_permlane32_swap_b32 v11, v13
    s_nop 1
    v_max_f32 v10, v10, v12
    v_max_f32 v11, v11, v13
    s_mov_b32 s38, 0
L_x1:
    s_lshr_b32 s32, s38, 1
    s_mul_i32 s32, s32, 9728
    s_add_u32 s32, s32, s36
    s_and_b32 s33, s38, 1
    s_mul_i32 s31, s33, 4608
    s_add_u32 s31, s31, s32
    s_lshl_b32 s30, s24, 10
    s_add_u32 s30, s30, s31
    buffer_load_dwordx4 v[32:35], v2, s[12:15], s30 offen offset:512 sc1
    s_lshl_b32 s30, s33, 7
    s_add_u32 s30, s30, s32
    s_lshl_b32 s33, s24, 8
    s_add_u32 s30, s30, s33
    buffer_load_dword v40, v4, s[12:15], s30 offen sc1
    s_mul_i32 s30, s24, 1280
    s_add_u32 s30, s30, s31
    s_add_u32 s30, s30, 2560
    buffer_load_dwordx4 v[44:47], v5, s[12:15], s30 offen sc1
    buffer_load_dwordx4 v[52:55], v5, s[12:15], s30 offen offset:640 sc1
    s_waitcnt vmcnt(0)
    v_mfma_f32_32x32x4_2b_bf16 v[96:127], v[40:41], v[24:25], 0 cbsz:1 abid:0
    s_nop 15
    s_nop 3
    v_mfma_f32_32x32x16_bf16 v[96:111], v[32:35], v[16:19], v[96:111]
    v_mfma_f32_32x32x16_bf16 v[112:127], v[32:35], v[20:23], v[112:127]
    s_nop 15
    v_sub_f32 v96, v96, v10
    v_sub_f32 v112, v112, v11
    v_sub_f32 v97, v97, v10
    v_sub_f32 v113, v113, v11
    v_sub_f32 v98, v98, v10
    v_sub_f32 v114, v114, v11
    v_sub_f32 v99, v99, v10
    v_sub_f32 v115, v115, v11
    v_sub_f32 v100, v100, v10
    v_sub_f32 v116, v116, v11
    v_sub_f32 v101, v101, v10
    v_sub_f32 v117, v117, v11
    v_sub_f32 v102, v102, v10
    v_sub_f32 v118, v118, v11
    v_sub_f32 v103, v103, v10
    v_sub_f32 v119, v119, v11
    v_sub_f32 v104, v104, v10
    v_sub_f32 v120, v120, v11
    v_sub_f32 v105, v105, v10
    v_sub_f32 v121, v121, v11
    v_sub_f32 v106, v106, v10
    v_sub_f32 v122, v122, v11
    v_sub_f32 v107, v107, v10
    v_sub_f32 v123, v123, v11
    v_sub_f32 v108, v108, v10
    v_sub_f32 v124, v124, v11
    v_sub_f32 v109, v109, v10
    v_sub_f32 v125, v125, v11
    v_sub_f32 v110, v110, v10
    v_sub_f32 v126, v126, v11
    v_sub_f32 v111, v111, v10
    v_sub_f32 v127, v127, v11
    v_exp_f32 v96, v96
    v_exp_f32 v97, v97
    v_exp_f32 v98, v98
    v_exp_f32 v99, v99
    v_exp_f32 v100, v100
    v_exp_f32 v101, v101
    v_exp_f32 v102, v102
    v_exp_f32 v103, v103
    v_exp_f32 v104, v104
    v_exp_f32 v105, v105
    v_exp_f32 v106, v106
    v_exp_f32 v107, v107
    v_exp_f32 v108, v108
    v_exp_f32 v109, v109
    v_exp_f32 v110, v110
    v_exp_f32 v111, v111
    v_exp_f32 v112, v112
    v_exp_f32 v113, v113
    v_exp_f32 v114, v114
    v_exp_f32 v115, v115
    v_exp_f32 v116, v116
    v_exp_f32 v117, v117
    v_exp_f32 v118, v118
    v_exp_f32 v119, v119
    v_exp_f32 v120, v120
    v_exp_f32 v121, v121
    v_exp_f32 v122, v122
    v_exp_f32 v123, v123
    v_exp_f32 v124, v124
    v_exp_f32 v125, v125
    v_exp_f32 v126, v126
    v_exp_f32 v127, v127
    s_nop 1
    v_smfmac_f32_32x32x32_bf16 v[64:79], v[44:47], v[96:103], v6
    v_smfmac_f32_32x32x32_bf16 v[64:79], v[52:55], v[104:111], v6
    v_smfmac_f32_32x32x32_bf16 v[80:95], v[44:47], v[112:119], v6
    v_smfmac_f32_32x32x32_bf16 v[80:95], v[52:55], v[120:127], v6
    s_add_u32 s38, s38, 1
    s_cmp_lt_u32 s38, 64
    s_cbranch_scc1 L_x1
    s_nop 15
    s_branch L_fin
L_end:
L_done:
    s_endpgm
.section .rodata,"a"
.p2align 6
.amdhsa_kernel gated_mix__mha_block__mha_block__prompt_kernel
  .amdhsa_next_free_vgpr 168
  .amdhsa_next_free_sgpr 72
  .amdhsa_accum_offset 168
  .amdhsa_group_segment_fixed_size 0
  .amdhsa_kernarg_size 80
  .amdhsa_user_sgpr_count 2
  .amdhsa_user_sgpr_kernarg_segment_ptr 1
  .amdhsa_system_sgpr_workgroup_id_x 1
.end_amdhsa_kernel
```
